```python
import torch

def _softmax(x, axis=-1):
    return torch.softmax(x, dim=axis)
def _gelu(x):
    return torch.nn.functional.gelu(x, approximate="tanh")
def _silu(x):
    return torch.nn.functional.silu(x)
def _sigmoid(x):
    return torch.sigmoid(x)
def _layernorm(x, axis=-1, eps=1e-5):
    m = x.mean(dim=axis, keepdim=True)
    v = x.var(dim=axis, keepdim=True, unbiased=False)
    return (x - m) / torch.sqrt(v + eps)
def _scatter_add(tgt, idx, src, axis=0):
    return tgt.clone().index_add_(axis, idx, src)
def _segment_sum(src, seg, n):
    out = torch.zeros((n,) + src.shape[1:], dtype=src.dtype)
    return out.index_add_(0, seg, src)
def _pad(x, pw):
    flat = tuple(v for pair in reversed(pw) for v in pair)
    return torch.nn.functional.pad(x, flat)

kernel_name = 'standalone__modern_conv_block_convnext__vision'

def setup_inputs():

    _w = (lambda a: (lambda t: t.to(torch.bfloat16) if t.is_floating_point() else t)(torch.as_tensor(a)))
    H = W = 224
    C = 96
    K = 7
    return {
        "x": _w((lambda *s: torch.randn(*s, dtype=torch.bfloat16) * 0.05)(1, H, W, C)),
        "dw": _w((lambda *s: torch.randn(*s, dtype=torch.bfloat16) * 0.05)(K, K, C)),
        "w1": _w((lambda *s: torch.randn(*s, dtype=torch.bfloat16) * 0.05)(C, 4 * C)),
        "b1": _w((lambda *s: torch.randn(*s, dtype=torch.bfloat16) * 0.2)(4 * C)),
        "w2": _w((lambda *s: torch.randn(*s, dtype=torch.bfloat16) * 0.05)(4 * C, C)),
        "b2": _w((lambda *s: torch.randn(*s, dtype=torch.bfloat16) * 0.4)(C)),
        "gamma": _w((lambda *s: torch.randn(*s, dtype=torch.bfloat16) * 0.05)(C)),
    }

def reference(x, dw, w1, b1, w2, b2, gamma):
    B, H, W, C = x.shape
    K = dw.shape[0]
    pad = K // 2
    xp = _pad(x, ((0,0),(pad,pad),(pad,pad),(0,0)))
    out = torch.zeros_like(x)
    for i in range(K):
        for j in range(K):
            out = out + xp[:, i:i+H, j:j+W, :] * dw[i, j][None, None, None, :]
    h = _layernorm(out, axis=-1)
    h = torch.einsum('bhwc,ce->bhwe', h, w1) + b1
    h = _gelu(h)
    h = torch.einsum('bhwe,ec->bhwc', h, w2) + b2
    return x + gamma[None, None, None, :] * h
```

```asm
; @launch grid=(256,1,1) block=(256,1,1) lds=163840
.amdgcn_target "amdgcn-amd-amdhsa--gfx950"
.text
.globl standalone__modern_conv_block_convnext__vision_kernel
.p2align 8
.type standalone__modern_conv_block_convnext__vision_kernel,@function
standalone__modern_conv_block_convnext__vision_kernel:
    s_load_dwordx16 s[4:19], s[0:1], 0
    s_cmp_ge_u32 s2, 256
    s_cbranch_scc1 L_end
    s_getpc_b64 s[20:21]
    s_lshr_b32 s22, s2, 3
    v_lshrrev_b32 v250, 5, v0
    s_add_u32 s23, s20, 0xa8b
    v_lshl_add_u32 v250, s22, 3, v250
    s_and_b32 s23, s23, 0xfffff000
    s_sub_u32 s23, s23, s20
    v_lshlrev_b32 v250, 7, v250
    s_add_u32 s24, s23, 0x1000
    s_cmp_lt_u32 s22, 4
    s_cselect_b32 s23, 0, s23
    s_mov_b32 s22, 0x696c
    s_cselect_b32 s22, 0xa0c, s22
    v_min_u32 v250, s22, v250
    v_mov_b32 v251, s21
    v_add_u32 v250, s23, v250
    v_add_co_u32 v250, vcc, s20, v250
    s_nop 1
    v_addc_co_u32 v251, vcc, 0, v251, vcc
    global_load_dword a255, v[250:251], off
    v_lshrrev_b32 v178, 6, v0
    s_and_b32 s3, s2, 1
    v_and_b32 v251, 63, v0
    s_bfe_u32 s100, s2, 0x20003
    v_readfirstlane_b32 s48, v178
    s_lshl2_add_u32 s3, s3, s100
    v_lshlrev_b32 v177, 4, v0
    s_bfe_u32 s100, s2, 0x20001
    v_mul_u32_u24 v210, 171, v0
    s_bfe_u32 s101, s2, 0x20005
    s_lshr_b32 s52, s2, 7
    v_lshrrev_b32 v210, 11, v210
    s_lshl1_add_u32 s101, s101, s52
    v_bfrev_b32 v212, 1
    s_lshl3_add_u32 s100, s100, s101
    v_mov_b32 v211, 36096
    s_mul_i32 s51, s100, 301056
    v_mul_u32_u24 v244, 12, v210
    s_mul_i32 s101, s3, 5376
    v_sub_u32 v209, v0, v244
    s_add_u32 s51, s51, s101
    s_sub_u32 s52, s51, 129792
    v_mul_u32_u24 v244, 8224, v209
    s_cmp_eq_u32 s3, 0
    v_lshrrev_b32 v209, 2, v209
    s_cselect_b32 s53, 4, 0
    v_mad_i32_i24 v244, v209, -8, v244
    s_cmp_eq_u32 s3, 7
    v_lshl_add_u32 v244, v210, 2, v244
    s_cselect_b32 s55, 32, 36
    s_sub_u32 s55, s55, s53
    v_cmp_gt_u32 vcc, 21, v210
    v_lshl_add_u32 v208, v0, 4, s52
    v_subrev_u32 v209, s53, v210
    v_cndmask_b32 v208, v212, v208, vcc
    s_and_b32 s49, s48, 1
    v_add_u32 v213, 0, v209
    v_cmp_gt_u32 vcc, s55, v213
    v_add_u32 v240, 0, v208
    s_lshr_b32 s50, s48, 1
    s_nop 0
    v_cndmask_b32 v240, v212, v240, vcc
    v_add_u32 v241, 301056, v240
    s_mul_i32 s3, s49, 96
    v_mad_u32_u24 v14, v178, 48, v251
    v_subrev_u32 v15, 24, v251
    v_lshlrev_b32 v14, 2, v14
    v_min_u32_e64 v15, v15, v251
    v_lshl_add_u32 v15, v15, 2, s3
    s_mov_b32 s26, 9408
    s_mov_b32 s22, 9633792
    s_mov_b32 s38, 768
    s_mov_b32 s42, 192
    s_mov_b32 s27, 0x20000
    s_mov_b32 s23, 0x20000
    s_mov_b32 s39, 0x20000
    s_mov_b32 s43, 0x20000
    s_lshl_b32 s3, s48, 10
    s_add_u32 m0, s3, 131072
    s_movk_i32 s99, 4096
    s_movk_i32 s100, 8192
    s_cmp_eq_u32 s50, 0
    s_waitcnt lgkmcnt(0)
    s_mov_b64 s[24:25], s[6:7]
    buffer_load_dwordx4 v177, s[24:27], 0 offen lds
    s_cselect_b64 s[40:41], s[14:15], s[16:17]
    s_add_u32 m0, m0, 4096
    s_mov_b64 s[20:21], s[4:5]
    buffer_load_dwordx4 v177, s[24:27], s99 offen lds
    s_add_u32 m0, m0, 4096
    s_mov_b64 s[36:37], s[10:11]
    buffer_load_dwordx4 v177, s[24:27], s100 offen lds
    buffer_load_dword v254, v14, s[36:39], 0 offen
    buffer_load_dword v255, v15, s[40:43], 0 offen
    buffer_load_dwordx4 v[32:35], v240, s[20:23], 0 offen
    buffer_load_dwordx4 v[36:39], v241, s[20:23], 0 offen
    s_mov_b32 s54, 4032
    v_cmp_le_u32 s[86:87], 15, v210
    v_add_u32 v213, 21, v209
    v_subrev_u32_e64 v214, 36, v213
    v_cndmask_b32 v213, v213, v214, s[86:87]
    v_cndmask_b32 v214, 0, v211, s[86:87]
    v_cmp_gt_u32 s[6:7], s55, v213
    v_add3_u32 v242, v208, v214, s54
    s_nop 0
    v_cndmask_b32 v242, v212, v242, s[6:7]
    v_add_u32 v243, 301056, v242
    buffer_load_dwordx4 v[40:43], v242, s[20:23], 0 offen
    buffer_load_dwordx4 v[44:47], v243, s[20:23], 0 offen
    v_add_u32 v240, 44160, v208
    v_add_u32 v241, 301056, v240
    buffer_load_dwordx4 v[48:51], v240, s[20:23], 0 offen
    buffer_load_dwordx4 v[52:55], v241, s[20:23], 0 offen
    s_mov_b32 s54, 48192
    v_cmp_le_u32 s[86:87], 9, v210
    v_add_u32 v213, 27, v209
    v_subrev_u32_e64 v214, 36, v213
    v_cndmask_b32 v213, v213, v214, s[86:87]
    v_cndmask_b32 v214, 0, v211, s[86:87]
    v_cmp_gt_u32 s[6:7], s55, v213
    v_add3_u32 v242, v208, v214, s54
    s_nop 0
    v_cndmask_b32 v242, v212, v242, s[6:7]
    v_add_u32 v243, 301056, v242
    buffer_load_dwordx4 v[56:59], v242, s[20:23], 0 offen
    buffer_load_dwordx4 v[60:63], v243, s[20:23], 0 offen
    v_mov_b64 v[188:189], 0
    s_mul_i32 s76, s48, 6144
    s_mov_b32 s56, 0x05040100
    s_mov_b64 s[28:29], s[8:9]
    v_mov_b64 v[190:191], 0
    s_mov_b32 s30, 73728
    s_mov_b32 s31, 0x20000
    s_mov_b64 s[32:33], s[12:13]
    v_mfma_f32_32x32x16_bf16 v[192:207], v[188:191], v[188:191], 0
    s_mov_b64 s[34:35], s[30:31]
    s_mov_b64 s[44:45], s[18:19]
    s_mov_b64 s[46:47], s[22:23]
    v_mul_u32_u24 v174, 43, v251
    v_lshrrev_b32 v174, 8, v174
    v_mul_u32_u24 v175, 6, v174
    v_sub_u32 v175, v251, v175
    v_mul_u32_u24 v176, 1344, v174
    v_lshl_add_u32 v176, v175, 3, v176
    v_mad_u32_u24 v176, v178, 48, v176
    s_mul_i32 s3, s48, 6432
    v_bfe_u32 v179, v251, 1, 3
    s_add_u32 s3, s3, 98816
    v_lshrrev_b32 v180, 4, v251
    v_and_b32 v181, 1, v251
    v_lshl_add_u32 v181, v181, 4, s3
    v_mov_b32 v184, 0x8888
    v_mov_b32 v185, 0xdddd
    v_cmp_lt_u32 vcc, v180, v179
    v_sub_u32 v182, v180, v179
    v_add_u32 v183, 7, v182
    v_cndmask_b32 v249, v184, v185, vcc
    v_min_u32 v183, v182, v183
    v_lshl_add_u32 v247, v183, 5, v181
    v_cmp_gt_i32 vcc, -4, v182
    v_cmp_eq_u32 s[90:91], 3, v180
    v_add_u32 v183, 4, v182
    v_add_u32 v182, 11, v182
    v_min_u32 v182, v182, v183
    v_cndmask_b32 v183, v184, v185, vcc
    v_cndmask_b32 v182, v182, 7, s[90:91]
    v_lshl_or_b32 v249, v183, 16, v249
    v_lshl_add_u32 v248, v182, 5, v181
    v_mul_u32_u24 v177, 1072, v175
    v_lshl_add_u32 v177, v174, 5, v177
    v_add_u32 v177, s3, v177
    v_lshlrev_b32 v1, 4, v251
    s_mul_i32 s3, s48, 3
    s_lshr_b32 s100, s3, 2
    s_mul_i32 s3, s3, 8224
    s_lshl_b32 s100, s100, 3
    s_sub_u32 s3, s3, s100
    v_and_b32_e64 v224, 15, v251
    v_bfe_u32 v225, v251, 4, 1
    s_mov_b32 s57, 0x07060302
    v_lshl_add_u32 v226, v225, 1, v224
    v_lshl_add_u32 v252, v226, 3, s3
    v_lshrrev_b32 v227, 5, v251
    v_mul_u32_u24 v227, 144, v227
    v_add_u32 v253, v252, v227
    v_cmp_gt_u32 vcc, 21, v210
    v_cmp_gt_u32 s[88:89], 48, v251
    v_add_u32 v227, 147968, v1
    v_add_u32_e64 v213, 12, v209
    v_cmp_gt_u32 s[6:7], s55, v213
    v_add_u32 v240, 88320, v208
    s_nop 0
    v_cndmask_b32 v240, v212, v240, s[6:7]
    v_add_u32 v241, 301056, v240
    buffer_load_dwordx4 v[64:67], v240, s[20:23], 0 offen
    buffer_load_dwordx4 v[68:71], v241, s[20:23], 0 offen
    v_mov_b32 v226, 147968
    v_cndmask_b32_e64 v244, v226, v244, vcc
    v_cndmask_b32 v177, v227, v177, s[88:89]
    s_mul_i32 s24, s50, 384
    s_mul_i32 s25, s49, 36864
    s_add_u32 s24, s24, s25
    s_mul_i32 s25, s50, 24576
    s_add_u32 s25, s25, s76
    s_mul_i32 s26, s48, 9456
    v_lshrrev_b32 v234, 3, v251
    v_mul_u32_u24 v234, 768, v234
    v_bfe_u32 v233, v251, 4, 1
    v_lshlrev_b32 v233, 2, v233
    v_and_b32 v235, 7, v251
    v_xor_b32 v233, v233, v235
    v_lshl_add_u32 v234, v233, 4, v234
    v_add_u32 v24, s24, v234
    v_add_u32 v25, s25, v1
    v_and_b32 v232, 15, v251
    v_lshrrev_b32 v234, 4, v251
    v_mad_u32_u24 v234, v234, 28, v232
    v_lshlrev_b32_e64 v234, 1, v234
    s_mov_b32 s92, 5120
    s_mov_b32 s93, 10240
    s_mov_b32 s94, 15360
    s_mov_b32 s95, 24576
    s_mov_b32 s96, 29696
    v_add_u32 v250, -1, v234
    v_bfe_u32 v235, v250, 3, 1
    v_xor_b32 v250, v250, v235
    v_lshl_add_u32 v250, v250, 4, s26
    v_add_u32 v245, 0, v234
    v_bfe_u32 v235, v245, 3, 1
    v_xor_b32 v245, v245, v235
    v_lshl_add_u32 v245, v245, 4, s26
    v_add_u32_e64 v15, 27, v234
    v_bfe_u32 v235, v15, 3, 1
    v_xor_b32_e64 v15, v15, v235
    v_lshl_add_u32 v15, v15, 4, s26
    v_add_u32_e64 v246, 28, v234
    v_bfe_u32 v235, v246, 3, 1
    v_xor_b32_e64 v246, v246, v235
    v_lshl_add_u32 v246, v246, 4, s26
    v_subrev_u32_e64 v233, 1, v232
    v_cmp_gt_u32 s[36:37], 14, v232
    v_cmp_gt_u32_e64 vcc, 14, v233
    v_add_u32 v234, 38400, v1
    v_cndmask_b32 v245, v234, v245, s[36:37]
    v_cndmask_b32_e64 v250, v234, v250, vcc
    v_cndmask_b32 v246, v234, v246, s[36:37]
    v_cmp_gt_u32 s[36:37], 48, v251
    v_cndmask_b32_e64 v15, v234, v15, vcc
    s_movk_i32 s99, 4096
    v_cndmask_b32 v246, v234, v246, s[36:37]
    v_cndmask_b32 v15, v234, v15, s[36:37]
    v_lshrrev_b32_e64 v232, 5, v251
    v_bfe_u32 v233, v251, 4, 1
    v_bfe_u32 v234, v251, 2, 2
    s_mul_i32 s41, s50, 3
    s_add_u32 s39, s41, s49
    s_sub_u32 s40, s41, s49
    s_add_u32 s40, s40, 1
    s_add_u32 s41, s41, 2
    s_mov_b64 exec, 0
    s_cmp_eq_u32 s48, 0
    s_cbranch_scc1 L_pad0
    s_cmp_eq_u32 s48, 1
    s_cbranch_scc1 L_pad1
    s_cmp_eq_u32 s48, 2
    s_cbranch_scc1 L_pad2
    s_branch L_pad3
L_go:
    s_mov_b64 exec, -1
    s_waitcnt vmcnt(12)
    s_barrier
    v_add_u32 v176, 131072, v176
    ds_read_b64 v[160:161], v176 offset:0
    ds_read_b64 v[162:163], v176 offset:192
    ds_read_b64 v[164:165], v176 offset:384
    ds_read_b64 v[166:167], v176 offset:576
    ds_read_b64 v[168:169], v176 offset:768
    ds_read_b64 v[170:171], v176 offset:960
    ds_read_b64 v[172:173], v176 offset:1152
    s_waitcnt vmcnt(11)
    v_lshlrev_b32 v224, 16, v254
    v_and_b32 v225, 0xffff0000, v254
    s_mov_b32 s3, 0x40088e99
    s_waitcnt vmcnt(10)
    v_lshlrev_b32 v226, 16, v255
    v_and_b32 v227, 0xffff0000, v255
    s_cmp_eq_u32 s50, 0
    s_cselect_b32 s3, 0x3eeff558, s3
    v_mul_f32 v224, 0x3eeff558, v224
    v_mul_f32 v225, 0x3eeff558, v225
    s_mul_i32 s100, s48, 288
    v_lshlrev_b32 v228, 1, v14
    v_add_u32 v228, 156160, v228
    s_add_u32 s100, s100, 157696
    v_mul_f32 v226, s3, v226
    v_mul_f32_e64 v227, s3, v227
    v_lshl_add_u32 v229, v251, 3, s100
    s_mov_b32 exec_hi, 0xffff
    ds_write_b64 v228, v[224:225]
    s_mov_b32 exec_hi, 0xf
    ds_write_b64 v229, v[226:227]
    s_mov_b32 exec_hi, -1
    s_mov_b32 s54, 92352
    v_cmp_le_u32 s[86:87], 3, v210
    v_add_u32 v213, 33, v209
    v_subrev_u32 v214, 36, v213
    v_cndmask_b32 v213, v213, v214, s[86:87]
    v_cndmask_b32 v214, 0, v211, s[86:87]
    v_cmp_gt_u32 s[6:7], s55, v213
    v_add3_u32 v242, v208, v214, s54
    s_nop 0
    v_cndmask_b32 v242, v212, v242, s[6:7]
    v_add_u32 v243, 301056, v242
    buffer_load_dwordx4 v[72:75], v242, s[20:23], 0 offen
    buffer_load_dwordx4 v[76:79], v243, s[20:23], 0 offen
    s_waitcnt lgkmcnt(7)
    v_perm_b32 v128, v162, v160, s56
    s_waitcnt lgkmcnt(5)
    v_perm_b32 v129, v166, v164, s56
    s_waitcnt lgkmcnt(3)
    v_perm_b32 v130, v170, v168, s56
    s_waitcnt lgkmcnt(2)
    v_and_b32 v131, 0xffff, v172
    ds_write_b128 v177, v[128:131] offset:0
    s_mul_i32 s97, s49, 48
    s_sub_u32 s98, 48, s97
    s_mul_i32 s42, s49, 6
    s_add_u32 s42, s42, s50
    s_lshl_b32 s42, s42, 7
    s_add_u32 s42, s42, 156160
    v_lshlrev_b32_e64 v132, 16, v160
    v_perm_b32 v133, v164, v162, s56
    v_perm_b32 v134, v168, v166, s56
    v_perm_b32 v135, v172, v170, s56
    ds_write_b128 v177, v[132:135] offset:16
    s_lshl1_add_u32 s43, s97, 157696
    s_sub_u32 s74, s40, s39
    s_lshl_b32 s74, s74, 9
    s_sub_u32 s75, s41, s40
    s_lshl_b32 s75, s75, 9
    s_lshl_b32 s39, s39, 9
    v_perm_b32 v136, v162, v160, s57
    v_perm_b32 v137, v166, v164, s57
    v_perm_b32 v138, v170, v168, s57
    v_lshrrev_b32 v139, 16, v172
    ds_write_b128 v177, v[136:139] offset:256
    s_mov_b32 s58, 0xc09d30fc
    s_mov_b32 s59, 0xc09d30fc
    s_mov_b32 s60, 1.0
    s_mov_b32 s61, 1.0
    v_lshl_add_u32 v3, v232, 4, s42
    v_xor_b32 v4, 0x80, v3
    v_and_b32 v140, 0xffff0000, v160
    v_perm_b32 v141, v164, v162, s57
    v_perm_b32 v142, v168, v166, s57
    v_perm_b32 v143, v172, v170, s57
    ds_write_b128 v177, v[140:143] offset:272
    v_mul_u32_u24 v236, 288, v232
    v_add_u32 v5, s43, v236
    v_and_b32 v235, 31, v251
    v_mul_u32_u24 v236, 3152, v232
    v_add_u32 v30, 3072, v236
    v_bfe_u32 v237, v251, 3, 1
    v_xor_b32 v237, v237, v235
    s_mov_b32 s54, 132480
    v_cmp_le_u32 s[86:87], 18, v210
    v_add_u32 v213, 18, v209
    v_subrev_u32_e64 v214, 36, v213
    v_cndmask_b32 v213, v213, v214, s[86:87]
    v_cndmask_b32 v214, 0, v211, s[86:87]
    v_cmp_gt_u32 s[6:7], s55, v213
    v_add3_u32 v240, v208, v214, s54
    s_nop 0
    v_cndmask_b32 v240, v212, v240, s[6:7]
    v_add_u32 v241, 301056, v240
    buffer_load_dwordx4 v[80:83], v240, s[20:23], 0 offen
    buffer_load_dwordx4 v[84:87], v241, s[20:23], 0 offen
    v_perm_b32 v144, v163, v161, s56
    v_perm_b32 v145, v167, v165, s56
    v_perm_b32 v146, v171, v169, s56
    v_and_b32 v147, 0xffff, v173
    ds_write_b128 v177, v[144:147] offset:512
    v_lshl_add_u32 v236, v237, 4, v236
    v_add_u32 v13, s39, v236
    v_lshlrev_b32 v236, 6, v234
    v_bfe_u32 v237, v251, 3, 1
    v_lshl_add_u32 v236, v237, 7, v236
    v_add_u32 v237, v233, v232
    v_lshlrev_b32_e64 v148, 16, v161
    v_perm_b32 v149, v165, v163, s56
    v_perm_b32 v150, v169, v167, s56
    v_perm_b32 v151, v173, v171, s56
    ds_write_b128 v177, v[148:151] offset:528
    v_lshl_add_u32 v236, v237, 4, v236
    v_add_u32_e64 v31, v236, v3
    v_add_u32 v2, 37632, v1
    s_mul_i32 s24, s48, 6656
    s_add_u32 s24, s24, 98816
    s_mul_i32 s71, s40, 43776
    v_perm_b32 v152, v163, v161, s57
    v_perm_b32 v153, v167, v165, s57
    v_perm_b32 v154, v171, v169, s57
    v_lshrrev_b32 v155, 16, v173
    ds_write_b128 v177, v[152:155] offset:768
    s_add_u32 s71, s71, s51
    s_mul_i32 s73, s41, 43776
    s_add_u32 s73, s73, s51
    s_lshl_b32 s40, s40, 2
    s_sub_u32 s40, 28, s40
    s_lshl_b32 s41, s41, 2
    v_and_b32 v156, 0xffff0000, v161
    v_perm_b32 v157, v165, v163, s57
    v_perm_b32 v158, v169, v167, s57
    v_perm_b32 v159, v173, v171, s57
    ds_write_b128 v177, v[156:159] offset:784
    s_sub_u32 s41, 28, s41
    s_mul_i32 s62, s40, 192
    s_mul_i32 s68, s41, 192
    v_mul_u32_u24 v237, 96, v232
    v_mul_u32_u24 v238, 208, v235
    v_add3_u32 v238, v238, v237, s24
    v_add_u32 v6, s97, v238
    s_branch L_main
.p2align 12
L_main:
L_pad0:
    s_cbranch_execz L_go
    v_add_u32_e64 v213, 3, v209
    v_cmp_gt_u32 s[6:7], s55, v213
    v_add_u32 v242, 172608, v208
    s_nop 0
    v_cndmask_b32 v242, v212, v242, s[6:7]
    v_add_u32 v243, 301056, v242
    buffer_load_dwordx4 v[88:91], v242, s[20:23], 0 offen
    buffer_load_dwordx4 v[92:95], v243, s[20:23], 0 offen
    ds_read_b128 a[0:3], v247 offset:0
    ds_read_b128 a[4:7], v248 offset:0
    ds_read_b128 a[8:11], v247 offset:256
    ds_read_b128 a[12:15], v248 offset:256
    v_add_u32 v7, s98, v238
    v_mul_u32_u24 v238, 192, v235
    v_cmp_le_u32 vcc, s40, v235
    v_cmp_le_u32 s[36:37], s41, v235
    v_add_u32_e64 v238, v238, v237
    v_add_u32 v237, 37632, v238
    ds_read_b128 a[16:19], v247 offset:512
    ds_read_b128 a[20:23], v248 offset:512
    ds_read_b128 a[24:27], v247 offset:768
    ds_read_b128 a[28:31], v248 offset:768
    v_cndmask_b32 v11, v238, v237, vcc
    v_cndmask_b32 v12, v238, v237, s[36:37]
    v_mfma_f32_32x32x16_bf16 v[128:143], v[188:191], v[188:191], 0
    v_add_u32 v11, s71, v11
    v_add_u32_e64 v12, s73, v12
    s_mul_i32 s25, s49, 3072
    ds_read_b128 a[32:35], v247 offset:1072
    ds_read_b128 a[36:39], v248 offset:1072
    ds_read_b128 a[40:43], v247 offset:1328
    ds_read_b128 a[44:47], v248 offset:1328
    s_sub_u32 s68, s68, s25
    s_add_u32 s73, s73, s25
    s_add_u32 s72, s71, 4096
    s_sub_u32 s63, s62, 1024
    v_mfma_f32_32x32x16_bf16 v[144:159], v[188:191], v[188:191], 0
    s_sub_u32 s64, s63, 1024
    ds_read_b128 a[48:51], v247 offset:1584
    ds_read_b128 a[52:55], v248 offset:1584
    ds_read_b128 a[56:59], v247 offset:1840
    ds_read_b128 a[60:63], v248 offset:1840
    s_sub_u32 s65, s64, 1024
    s_sub_u32 s66, s65, 1024
    s_sub_u32 s67, s66, 1024
    s_sub_u32 s69, s68, 1024
    s_sub_u32 s70, s69, 1024
    v_add_u32_e64 v236, 0, v251
    v_mfma_f32_32x32x16_bf16 v[160:175], v[188:191], v[188:191], 0
    s_mov_b32 s54, 176640
    v_cmp_le_u32 s[86:87], 12, v210
    v_add_u32 v213, 24, v209
    v_subrev_u32 v214, 36, v213
    v_cndmask_b32 v213, v213, v214, s[86:87]
    v_cndmask_b32 v214, 0, v211, s[86:87]
    v_cmp_gt_u32 s[6:7], s55, v213
    v_add3_u32 v240, v208, v214, s54
    s_nop 0
    v_cndmask_b32 v240, v212, v240, s[6:7]
    v_add_u32 v241, 301056, v240
    buffer_load_dwordx4 v[96:99], v240, s[20:23], 0 offen
    buffer_load_dwordx4 v[100:103], v241, s[20:23], 0 offen
    ds_read_b128 a[64:67], v247 offset:2144
    ds_read_b128 a[68:71], v248 offset:2144
    ds_read_b128 a[72:75], v247 offset:2400
    ds_read_b128 a[76:79], v248 offset:2400
    v_mul_u32_u24 v238, 171, v236
    v_lshrrev_b32 v238, 11, v238
    v_add_u32 v236, v236, v238
    v_lshl_add_u32 v8, v236, 4, s24
    v_add_u32 v236, 64, v251
    v_mul_u32_u24 v238, 171, v236
    ds_read_b128 a[80:83], v247 offset:2656
    ds_read_b128 a[84:87], v248 offset:2656
    ds_read_b128 a[88:91], v247 offset:2912
    ds_read_b128 a[92:95], v248 offset:2912
    v_lshrrev_b32 v238, 11, v238
    v_add_u32 v236, v236, v238
    v_mov_b64_e64 v[176:177], 0
    v_lshl_add_u32 v9, v236, 4, s24
    v_add_u32 v236, 128, v251
    v_mul_u32_u24 v238, 171, v236
    ds_read_b128 a[96:99], v247 offset:3216
    ds_read_b128 a[100:103], v248 offset:3216
    ds_read_b128 a[104:107], v247 offset:3472
    ds_read_b128 a[108:111], v248 offset:3472
    v_lshrrev_b32 v238, 11, v238
    v_add_u32 v236, v236, v238
    v_lshl_add_u32 v10, v236, 4, s24
    v_and_b32 v236, 1, v234
    v_mov_b64 v[178:179], 0
    v_cmp_eq_u32_e64 vcc, v236, v232
    ds_read_b128 a[112:115], v247 offset:3728
    ds_read_b128 a[116:119], v248 offset:3728
    ds_read_b128 a[120:123], v247 offset:3984
    ds_read_b128 a[124:127], v248 offset:3984
    v_and_b32 v236, 1, v251
    v_lshlrev_b32 v236, 4, v236
    v_mov_b32 v237, 0x3f80
    v_lshlrev_b32 v237, v236, v237
    v_cndmask_b32 v237, 0, v237, vcc
    v_bfe_u32 v236, v251, 3, 2
    v_mov_b64_e64 v[180:181], 0
    v_add_u32 v242, 216768, v208
    v_add_u32 v243, 301056, v242
    buffer_load_dwordx4 v[104:107], v242, s[20:23], 0 offen
    buffer_load_dwordx4 v[108:111], v243, s[20:23], 0 offen
    ds_read_b128 a[128:131], v247 offset:4288
    ds_read_b128 a[132:135], v248 offset:4288
    ds_read_b128 a[136:139], v247 offset:4544
    ds_read_b128 a[140:143], v248 offset:4544
    v_bfe_u32 v238, v251, 1, 1
    v_lshl_add_u32 v236, v236, 1, v238
    v_cmp_eq_u32 vcc, 0, v236
    v_cmp_eq_u32 s[36:37], 1, v236
    v_lshrrev_b32 v233, 2, v251
    v_cndmask_b32_e64 v16, 0, v237, vcc
    ds_read_b128 a[144:147], v247 offset:4800
    ds_read_b128 a[148:151], v248 offset:4800
    ds_read_b128 a[152:155], v247 offset:5056
    ds_read_b128 a[156:159], v248 offset:5056
    v_cndmask_b32 v17, 0, v237, s[36:37]
    v_cmp_eq_u32 vcc, 2, v236
    v_mov_b64 v[182:183], 0
    v_cmp_eq_u32 s[36:37], 3, v236
    v_and_b32 v235, 3, v251
    v_cndmask_b32 v18, 0, v237, vcc
    ds_read_b128 a[160:163], v247 offset:5360
    ds_read_b128 a[164:167], v248 offset:5360
    ds_read_b128 a[168:171], v247 offset:5616
    ds_read_b128 a[172:175], v248 offset:5616
    v_cndmask_b32 v19, 0, v237, s[36:37]
    v_cmp_eq_u32 vcc, 4, v236
    v_cmp_eq_u32 s[36:37], 5, v236
    v_add_u32 v234, 6, v233
    v_mov_b64 v[184:185], 0
    v_cndmask_b32 v20, 0, v237, vcc
    ds_read_b128 a[176:179], v247 offset:5872
    ds_read_b128 a[180:183], v248 offset:5872
    ds_read_b128 a[184:187], v247 offset:6128
    ds_read_b128 a[188:191], v248 offset:6128
    v_cndmask_b32 v21, 0, v237, s[36:37]
    v_cmp_eq_u32 vcc, 6, v236
    v_cmp_eq_u32 s[36:37], 7, v236
    v_subrev_u32 v238, 12, v234
    v_cndmask_b32 v22, 0, v237, vcc
    v_cndmask_b32 v23, 0, v237, s[36:37]
    v_mov_b64_e64 v[186:187], 0
    s_waitcnt vmcnt(18)
    v_perm_b32 v224, v36, v32, s56
    v_perm_b32 v225, v36, v32, s57
    v_perm_b32 v226, v37, v33, s56
    v_perm_b32 v227, v37, v33, s57
    s_mov_b32 s54, 220800
    v_cmp_le_u32 s[86:87], 6, v210
    v_add_u32 v213, 30, v209
    v_subrev_u32 v214, 36, v213
    v_cndmask_b32 v213, v213, v214, s[86:87]
    v_cndmask_b32 v214, 0, v211, s[86:87]
    v_cmp_gt_u32 s[6:7], s55, v213
    v_add3_u32 v240, v208, v214, s54
    s_nop 0
    v_cndmask_b32 v240, v212, v240, s[6:7]
    v_add_u32 v241, 301056, v240
    v_cndmask_b32 v241, v241, v212, s[86:87]
    buffer_load_dwordx4 v[112:115], v240, s[20:23], 0 offen
    buffer_load_dwordx4 v[116:119], v241, s[20:23], 0 offen
    ds_write2st64_b32 v244, v224, v225 offset0:0 offset1:4
    ds_write2st64_b32 v244, v226, v227 offset0:8 offset1:12
    v_perm_b32 v228, v38, v34, s56
    v_perm_b32 v229, v38, v34, s57
    v_perm_b32 v230, v39, v35, s56
    v_perm_b32 v231, v39, v35, s57
    ds_write2st64_b32 v244, v228, v229 offset0:16 offset1:20
    ds_write2st64_b32 v244, v230, v231 offset0:24 offset1:28
    v_add_u32 v244, 84, v244
    s_lshr_b32 s3, s2, 3
    s_mul_i32 s100, s48, 5
    v_min_u32 v32, 4, v251
    s_mul_i32 s3, s3, 2304
    v_add_u32 v32, s100, v32
    v_lshlrev_b32_e64 v32, 7, v32
    buffer_load_dword a254, v32, s[28:31], s3 offen
    buffer_load_dword a253, v32, s[32:35], s3 offen
    s_waitcnt vmcnt(20)
    v_perm_b32 v224, v44, v40, s56
    v_perm_b32 v225, v44, v40, s57
    v_perm_b32 v226, v45, v41, s56
    v_perm_b32 v227, v45, v41, s57
    v_add_u32 v213, 15, v209
    v_cmp_gt_u32 s[6:7], s55, v213
    v_add_u32 v242, 260928, v208
    s_nop 0
    v_cndmask_b32 v242, v212, v242, s[6:7]
    buffer_load_dwordx4 v[120:123], v242, s[20:23], 0 offen
    ds_write2st64_b32 v244, v224, v225 offset0:0 offset1:4
    ds_write2st64_b32 v244, v226, v227 offset0:8 offset1:12
    v_perm_b32 v228, v46, v42, s56
    v_perm_b32 v229, v46, v42, s57
    v_perm_b32 v230, v47, v43, s56
    v_perm_b32 v231, v47, v43, s57
    ds_write2st64_b32 v244, v228, v229 offset0:16 offset1:20
    ds_write2st64_b32 v244, v230, v231 offset0:24 offset1:28
    v_add_u32 v244, 84, v244
    s_waitcnt vmcnt(19)
    v_perm_b32 v224, v52, v48, s56
    v_perm_b32 v225, v52, v48, s57
    v_perm_b32 v226, v53, v49, s56
    v_perm_b32 v227, v53, v49, s57
    s_mul_i32 s24, s49, 12288
    s_add_u32 s25, s24, 49152
    s_add_u32 s24, s24, 73728
    s_mul_i32 s26, s49, 6
    ds_write2st64_b32 v244, v224, v225 offset0:0 offset1:4
    ds_write2st64_b32 v244, v226, v227 offset0:8 offset1:12
    v_perm_b32 v228, v54, v50, s56
    v_perm_b32 v229, v54, v50, s57
    v_perm_b32 v230, v55, v51, s56
    v_perm_b32 v231, v55, v51, s57
    ds_write2st64_b32 v244, v228, v229 offset0:16 offset1:20
    ds_write2st64_b32 v244, v230, v231 offset0:24 offset1:28
    v_add_u32 v244, 84, v244
    s_waitcnt vmcnt(17)
    v_perm_b32 v224, v60, v56, s56
    v_perm_b32 v225, v60, v56, s57
    v_perm_b32 v226, v61, v57, s56
    v_perm_b32 v227, v61, v57, s57
    s_mul_i32 s27, s50, 6144
    s_sub_u32 s38, 6144, s27
    v_lshrrev_b32 v232, 5, v251
    v_bfe_u32 v233, v251, 4, 1
    ds_write2st64_b32 v244, v224, v225 offset0:0 offset1:4
    ds_write2st64_b32 v244, v226, v227 offset0:8 offset1:12
    v_perm_b32 v228, v62, v58, s56
    v_perm_b32 v229, v62, v58, s57
    v_perm_b32 v230, v63, v59, s56
    v_perm_b32 v231, v63, v59, s57
    ds_write2st64_b32 v244, v228, v229 offset0:16 offset1:20
    ds_write2st64_b32 v244, v230, v231 offset0:24 offset1:28
    v_add_u32 v244, 84, v244
    v_mfma_f32_32x32x16_bf16 v[208:223], v[188:191], v[188:191], 0
    s_waitcnt vmcnt(15)
    v_perm_b32 v224, v68, v64, s56
    v_perm_b32 v225, v68, v64, s57
    v_perm_b32 v226, v69, v65, s56
    v_perm_b32 v227, v69, v65, s57
    v_bfe_u32 v234, v251, 2, 2
    v_and_b32 v235, 3, v251
    v_lshl_add_u32 v236, v232, 3, v234
    v_lshlrev_b32_e64 v236, 7, v236
    ds_write2st64_b32 v244, v224, v225 offset0:0 offset1:4
    ds_write2st64_b32 v244, v226, v227 offset0:8 offset1:12
    v_perm_b32 v228, v70, v66, s56
    v_perm_b32 v229, v70, v66, s57
    v_perm_b32 v230, v71, v67, s56
    v_perm_b32 v231, v71, v67, s57
    ds_write2st64_b32 v244, v228, v229 offset0:16 offset1:20
    ds_write2st64_b32 v244, v230, v231 offset0:24 offset1:28
    v_add_u32 v244, 84, v244
    s_waitcnt vmcnt(13)
    v_perm_b32 v224, v76, v72, s56
    v_perm_b32 v225, v76, v72, s57
    v_perm_b32 v226, v77, v73, s56
    v_perm_b32 v227, v77, v73, s57
    v_lshl_add_u32 v236, v233, 5, v236
    v_lshl_add_u32 v236, v235, 3, v236
    v_lshrrev_b32 v237, 1, v234
    v_xor_b32_e64 v237, s50, v237
    ds_write2st64_b32 v244, v224, v225 offset0:0 offset1:4
    ds_write2st64_b32 v244, v226, v227 offset0:8 offset1:12
    v_perm_b32 v228, v78, v74, s56
    v_perm_b32 v229, v78, v74, s57
    v_perm_b32 v230, v79, v75, s56
    v_perm_b32 v231, v79, v75, s57
    ds_write2st64_b32 v244, v228, v229 offset0:16 offset1:20
    ds_write2st64_b32 v244, v230, v231 offset0:24 offset1:28
    v_add_u32 v244, 84, v244
    s_waitcnt vmcnt(11)
    v_perm_b32 v224, v84, v80, s56
    v_perm_b32 v225, v84, v80, s57
    v_perm_b32 v226, v85, v81, s56
    v_perm_b32 v227, v85, v81, s57
    v_lshl_add_u32 v236, v237, 6, v236
    v_add_u32 v40, s24, v236
    v_xor_b32_e64 v41, 64, v40
    v_lshl_add_u32 v236, v232, 2, v234
    ds_write2st64_b32 v244, v224, v225 offset0:0 offset1:4
    ds_write2st64_b32 v244, v226, v227 offset0:8 offset1:12
    v_perm_b32 v228, v86, v82, s56
    v_perm_b32 v229, v86, v82, s57
    v_perm_b32 v230, v87, v83, s56
    v_perm_b32 v231, v87, v83, s57
    ds_write2st64_b32 v244, v228, v229 offset0:16 offset1:20
    ds_write2st64_b32 v244, v230, v231 offset0:24 offset1:28
    v_add_u32 v244, 84, v244
    s_waitcnt vmcnt(9)
    v_perm_b32 v224, v92, v88, s56
    v_perm_b32 v225, v92, v88, s57
    v_perm_b32 v226, v93, v89, s56
    v_perm_b32 v227, v93, v89, s57
    v_mul_u32_u24 v236, 192, v236
    v_and_b32 v237, 1, v235
    v_mul_u32_u24 v237, 96, v237
    v_add3_u32 v236, v236, v237, s25
    ds_write2st64_b32 v244, v224, v225 offset0:0 offset1:4
    ds_write2st64_b32 v244, v226, v227 offset0:8 offset1:12
    v_perm_b32 v228, v94, v90, s56
    v_perm_b32 v229, v94, v90, s57
    v_perm_b32 v230, v95, v91, s56
    v_perm_b32 v231, v95, v91, s57
    ds_write2st64_b32 v244, v228, v229 offset0:16 offset1:20
    ds_write2st64_b32 v244, v230, v231 offset0:24 offset1:28
    v_add_u32 v244, 84, v244
    s_waitcnt vmcnt(7)
    v_perm_b32 v224, v100, v96, s56
    v_perm_b32 v225, v100, v96, s57
    v_perm_b32 v226, v101, v97, s56
    v_perm_b32 v227, v101, v97, s57
    v_lshrrev_b32 v237, 1, v235
    v_lshl_add_u32 v237, v233, 1, v237
    v_add_u32 v237, s26, v237
    v_add_u32 v238, 0, v237
    ds_write2st64_b32 v244, v224, v225 offset0:0 offset1:4
    ds_write2st64_b32 v244, v226, v227 offset0:8 offset1:12
    v_perm_b32 v228, v102, v98, s56
    v_perm_b32 v229, v102, v98, s57
    v_perm_b32 v230, v103, v99, s56
    v_perm_b32 v231, v103, v99, s57
    ds_write2st64_b32 v244, v228, v229 offset0:16 offset1:20
    ds_write2st64_b32 v244, v230, v231 offset0:24 offset1:28
    v_add_u32 v244, 84, v244
    s_waitcnt vmcnt(5)
    v_perm_b32 v224, v108, v104, s56
    v_perm_b32 v225, v108, v104, s57
    v_perm_b32 v226, v109, v105, s56
    v_perm_b32 v227, v109, v105, s57
    v_subrev_u32 v235, 12, v238
    v_min_u32 v238, v238, v235
    v_lshl_add_u32 v238, v238, 3, v236
    v_add_u32 v42, s27, v238
    ds_write2st64_b32 v244, v224, v225 offset0:0 offset1:4
    ds_write2st64_b32 v244, v226, v227 offset0:8 offset1:12
    v_perm_b32 v228, v110, v106, s56
    v_perm_b32 v229, v110, v106, s57
    v_perm_b32 v230, v111, v107, s56
    v_perm_b32 v231, v111, v107, s57
    ds_write2st64_b32 v244, v228, v229 offset0:16 offset1:20
    ds_write2st64_b32 v244, v230, v231 offset0:24 offset1:28
    v_add_u32 v244, 84, v244
    s_waitcnt vmcnt(3)
    v_perm_b32 v224, v116, v112, s56
    v_perm_b32 v225, v116, v112, s57
    v_perm_b32 v226, v117, v113, s56
    v_perm_b32 v227, v117, v113, s57
    v_add_u32 v43, s38, v238
    v_add_u32 v238, 4, v237
    v_subrev_u32 v235, 12, v238
    v_min_u32_e64 v238, v238, v235
    ds_write2st64_b32 v244, v224, v225 offset0:0 offset1:4
    ds_write2st64_b32 v244, v226, v227 offset0:8 offset1:12
    v_perm_b32 v228, v118, v114, s56
    v_perm_b32 v229, v118, v114, s57
    v_perm_b32 v230, v119, v115, s56
    v_perm_b32 v231, v119, v115, s57
    ds_write2st64_b32 v244, v228, v229 offset0:16 offset1:20
    ds_write2st64_b32 v244, v230, v231 offset0:24 offset1:28
    v_add_u32 v244, 84, v244
    s_waitcnt vmcnt(0)
    v_perm_b32 v224, v124, v120, s56
    v_perm_b32 v225, v124, v120, s57
    v_perm_b32 v226, v125, v121, s56
    v_perm_b32 v227, v125, v121, s57
    v_lshl_add_u32 v238, v238, 3, v236
    v_add_u32 v44, s27, v238
    v_add_u32 v45, s38, v238
    v_add_u32 v238, 8, v237
    ds_write2st64_b32 v244, v224, v225 offset0:0 offset1:4
    ds_write2st64_b32 v244, v226, v227 offset0:8 offset1:12
    v_perm_b32 v228, v126, v122, s56
    v_perm_b32 v229, v126, v122, s57
    v_perm_b32 v230, v127, v123, s56
    v_perm_b32 v231, v127, v123, s57
    ds_write2st64_b32 v244, v228, v229 offset0:16 offset1:20
    ds_write2st64_b32 v244, v230, v231 offset0:24 offset1:28
    v_subrev_u32 v235, 12, v238
    v_min_u32 v238, v238, v235
    v_lshl_add_u32 v238, v238, 3, v236
    v_add_u32 v46, s27, v238
    v_add_u32 v47, s38, v238
    s_xor_b32 s25, s49, s50
    s_lshl_b32 s25, s25, 3
    s_andn2_b32 s24, s49, s50
    s_lshl_b32 s24, s24, 3
    v_subrev_u32 v240, s24, v252
    v_subrev_u32 v241, s24, v253
    v_subrev_u32 v242, s25, v252
    v_subrev_u32 v243, s25, v253
    s_lshl_b32 s26, s48, 11
    v_add_u32 v33, 147968, v1
    v_add_u32 v32, s26, v33
    v_min_u32 v34, 11, v251
    v_mul_u32_u24 v34, 3152, v34
    v_mov_b64 v[36:37], 0
    v_mov_b64_e64 v[38:39], 0
    s_waitcnt lgkmcnt(0)
    s_barrier
    ds_read_b64 v[48:49], v253 offset:0
    ds_read_b64 v[50:51], v253 offset:8
    ds_read_b64 v[52:53], v253 offset:288
    ds_read_b64 v[54:55], v253 offset:296
    ds_read_b64 v[56:57], v253 offset:1024
    ds_read_b64 v[58:59], v253 offset:1032
    ds_read_b64 v[60:61], v253 offset:1312
    ds_read_b64 v[62:63], v253 offset:1320
    ds_read_b64 v[64:65], v253 offset:2048
    ds_read_b64 v[66:67], v253 offset:2056
    ds_read_b64 v[68:69], v253 offset:2336
    ds_read_b64 v[70:71], v253 offset:2344
    s_waitcnt lgkmcnt(8)
    v_smfmac_f32_16x16x64_bf16 v[128:131], a[0:3], v[48:55], v249 abid:0
    s_nop 0
    ds_read_b64 v[72:73], v253 offset:3072
    ds_read_b64 v[74:75], v253 offset:3080
    ds_read_b64 v[76:77], v253 offset:3360
    ds_read_b64 v[78:79], v253 offset:3368
    s_waitcnt lgkmcnt(8)
    v_smfmac_f32_16x16x64_bf16 v[132:135], a[8:11], v[56:63], v249 abid:0
    s_nop 0
    ds_read_b64 v[48:49], v253 offset:4096
    ds_read_b64 v[50:51], v253 offset:4104
    ds_read_b64 v[52:53], v253 offset:4384
    ds_read_b64 v[54:55], v253 offset:4392
    s_waitcnt lgkmcnt(8)
    v_smfmac_f32_16x16x64_bf16 v[136:139], a[16:19], v[64:71], v249 abid:0
    s_nop 0
    ds_read_b64 v[56:57], v253 offset:5120
    ds_read_b64 v[58:59], v253 offset:5128
    ds_read_b64 v[60:61], v253 offset:5408
    ds_read_b64 v[62:63], v253 offset:5416
    s_waitcnt lgkmcnt(8)
    v_smfmac_f32_16x16x64_bf16 v[140:143], a[24:27], v[72:79], v249 abid:0
    s_nop 0
    ds_read_b64 v[64:65], v253 offset:6144
    ds_read_b64 v[66:67], v253 offset:6152
    ds_read_b64 v[68:69], v253 offset:6432
    ds_read_b64 v[70:71], v253 offset:6440
    s_waitcnt lgkmcnt(8)
    v_smfmac_f32_16x16x64_bf16 v[144:147], a[32:35], v[48:55], v249 abid:0
    s_nop 0
    ds_read_b64 v[72:73], v253 offset:7168
    ds_read_b64 v[74:75], v253 offset:7176
    ds_read_b64 v[76:77], v253 offset:7456
    ds_read_b64 v[78:79], v253 offset:7464
    s_waitcnt lgkmcnt(8)
    v_smfmac_f32_16x16x64_bf16 v[148:151], a[40:43], v[56:63], v249 abid:0
    s_nop 0
    ds_read_b64 v[48:49], v241 offset:8224
    ds_read_b64 v[50:51], v241 offset:8232
    ds_read_b64 v[52:53], v241 offset:8512
    ds_read_b64 v[54:55], v241 offset:8520
    s_waitcnt lgkmcnt(8)
    v_smfmac_f32_16x16x64_bf16 v[152:155], a[48:51], v[64:71], v249 abid:0
    s_nop 0
    ds_read_b64 v[56:57], v241 offset:9248
    ds_read_b64 v[58:59], v241 offset:9256
    ds_read_b64 v[60:61], v241 offset:9536
    ds_read_b64 v[62:63], v241 offset:9544
    s_waitcnt lgkmcnt(8)
    v_smfmac_f32_16x16x64_bf16 v[156:159], a[56:59], v[72:79], v249 abid:0
    s_nop 0
    ds_read_b64 v[64:65], v241 offset:10272
    ds_read_b64 v[66:67], v241 offset:10280
    ds_read_b64 v[68:69], v241 offset:10560
    ds_read_b64 v[70:71], v241 offset:10568
    s_waitcnt lgkmcnt(8)
    v_smfmac_f32_16x16x64_bf16 v[160:163], a[64:67], v[48:55], v249 abid:0
    s_nop 0
    ds_read_b64 v[72:73], v241 offset:11296
    ds_read_b64 v[74:75], v241 offset:11304
    ds_read_b64 v[76:77], v241 offset:11584
    ds_read_b64 v[78:79], v241 offset:11592
    s_waitcnt lgkmcnt(8)
    v_smfmac_f32_16x16x64_bf16 v[164:167], a[72:75], v[56:63], v249 abid:0
    s_nop 0
    ds_read_b64 v[48:49], v241 offset:12320
    ds_read_b64 v[50:51], v241 offset:12328
    ds_read_b64 v[52:53], v241 offset:12608
    ds_read_b64 v[54:55], v241 offset:12616
    s_waitcnt lgkmcnt(8)
    v_smfmac_f32_16x16x64_bf16 v[168:171], a[80:83], v[64:71], v249 abid:0
    s_nop 0
    ds_read_b64 v[56:57], v241 offset:13344
    ds_read_b64 v[58:59], v241 offset:13352
    ds_read_b64 v[60:61], v241 offset:13632
    ds_read_b64 v[62:63], v241 offset:13640
    s_waitcnt lgkmcnt(8)
    v_smfmac_f32_16x16x64_bf16 v[172:175], a[88:91], v[72:79], v249 abid:0
    s_nop 0
    ds_read_b64 v[64:65], v241 offset:14368
    ds_read_b64 v[66:67], v241 offset:14376
    ds_read_b64 v[68:69], v241 offset:14656
    ds_read_b64 v[70:71], v241 offset:14664
    s_waitcnt lgkmcnt(8)
    v_smfmac_f32_16x16x64_bf16 v[176:179], a[96:99], v[48:55], v249 abid:0
    s_nop 0
    ds_read_b64 v[72:73], v241 offset:15392
    ds_read_b64 v[74:75], v241 offset:15400
    ds_read_b64 v[76:77], v241 offset:15680
    ds_read_b64 v[78:79], v241 offset:15688
    s_waitcnt lgkmcnt(8)
    v_smfmac_f32_16x16x64_bf16 v[180:183], a[104:107], v[56:63], v249 abid:0
    s_nop 0
    ds_read_b64 v[48:49], v243 offset:16448
    ds_read_b64 v[50:51], v243 offset:16456
    ds_read_b64 v[52:53], v243 offset:16736
    ds_read_b64 v[54:55], v243 offset:16744
    s_waitcnt lgkmcnt(8)
    v_smfmac_f32_16x16x64_bf16 v[184:187], a[112:115], v[64:71], v249 abid:0
    s_nop 0
    ds_read_b64 v[56:57], v243 offset:17472
    ds_read_b64 v[58:59], v243 offset:17480
    ds_read_b64 v[60:61], v243 offset:17760
    ds_read_b64 v[62:63], v243 offset:17768
    s_waitcnt lgkmcnt(8)
    v_smfmac_f32_16x16x64_bf16 v[188:191], a[120:123], v[72:79], v249 abid:0
    s_nop 0
    ds_read_b64 v[64:65], v243 offset:18496
    ds_read_b64 v[66:67], v243 offset:18504
    ds_read_b64 v[68:69], v243 offset:18784
    ds_read_b64 v[70:71], v243 offset:18792
    s_waitcnt lgkmcnt(8)
    v_smfmac_f32_16x16x64_bf16 v[192:195], a[128:131], v[48:55], v249 abid:0
    s_nop 0
    ds_read_b64 v[72:73], v243 offset:19520
    ds_read_b64 v[74:75], v243 offset:19528
    ds_read_b64 v[76:77], v243 offset:19808
    ds_read_b64 v[78:79], v243 offset:19816
    s_waitcnt lgkmcnt(8)
    v_smfmac_f32_16x16x64_bf16 v[196:199], a[136:139], v[56:63], v249 abid:0
    s_nop 0
    ds_read_b64 v[48:49], v243 offset:20544
    ds_read_b64 v[50:51], v243 offset:20552
    ds_read_b64 v[52:53], v243 offset:20832
    ds_read_b64 v[54:55], v243 offset:20840
    s_waitcnt lgkmcnt(8)
    v_smfmac_f32_16x16x64_bf16 v[200:203], a[144:147], v[64:71], v249 abid:0
    s_nop 0
    ds_read_b64 v[56:57], v243 offset:21568
    ds_read_b64 v[58:59], v243 offset:21576
    ds_read_b64 v[60:61], v243 offset:21856
    ds_read_b64 v[62:63], v243 offset:21864
    s_waitcnt lgkmcnt(8)
    v_smfmac_f32_16x16x64_bf16 v[204:207], a[152:155], v[72:79], v249 abid:0
    s_nop 0
    ds_read_b64 v[64:65], v243 offset:22592
    ds_read_b64 v[66:67], v243 offset:22600
    ds_read_b64 v[68:69], v243 offset:22880
    ds_read_b64 v[70:71], v243 offset:22888
    s_waitcnt lgkmcnt(8)
    v_smfmac_f32_16x16x64_bf16 v[208:211], a[160:163], v[48:55], v249 abid:0
    s_nop 0
    ds_read_b64 v[72:73], v243 offset:23616
    ds_read_b64 v[74:75], v243 offset:23624
    ds_read_b64 v[76:77], v243 offset:23904
    ds_read_b64 v[78:79], v243 offset:23912
    s_waitcnt lgkmcnt(8)
    v_smfmac_f32_16x16x64_bf16 v[212:215], a[168:171], v[56:63], v249 abid:0
    s_nop 0
    ds_read_b64 v[48:49], v253 offset:576
    ds_read_b64 v[50:51], v253 offset:584
    ds_read_b64 v[52:53], v252 offset:864
    ds_read_b64 v[54:55], v252 offset:872
    s_waitcnt lgkmcnt(8)
    v_smfmac_f32_16x16x64_bf16 v[216:219], a[176:179], v[64:71], v249 abid:0
    s_nop 0
    ds_read_b64 v[56:57], v253 offset:1600
    ds_read_b64 v[58:59], v253 offset:1608
    ds_read_b64 v[60:61], v252 offset:1888
    ds_read_b64 v[62:63], v252 offset:1896
    s_waitcnt lgkmcnt(8)
    v_smfmac_f32_16x16x64_bf16 v[220:223], a[184:187], v[72:79], v249 abid:0
    s_nop 0
L_pad1:
    s_cbranch_execz L_go
    ds_read_b64 v[64:65], v253 offset:2624
    ds_read_b64 v[66:67], v253 offset:2632
    ds_read_b64 v[68:69], v252 offset:2912
    ds_read_b64 v[70:71], v252 offset:2920
    s_waitcnt lgkmcnt(8)
    v_smfmac_f32_16x16x64_bf16 v[128:131], a[4:7], v[48:55], v249 abid:1
    s_add_u32 m0, s76, 98816
    ds_read_b64 v[72:73], v253 offset:3648
    ds_read_b64 v[74:75], v253 offset:3656
    ds_read_b64 v[76:77], v252 offset:3936
    ds_read_b64 v[78:79], v252 offset:3944
    buffer_load_dwordx4 v24, s[28:31], 0 offen offset:0 lds
    s_waitcnt lgkmcnt(8)
    v_smfmac_f32_16x16x64_bf16 v[132:135], a[12:15], v[56:63], v249 abid:1
    s_nop 0
    ds_read_b64 v[48:49], v253 offset:4672
    ds_read_b64 v[50:51], v253 offset:4680
    ds_read_b64 v[52:53], v252 offset:4960
    ds_read_b64 v[54:55], v252 offset:4968
    s_waitcnt lgkmcnt(8)
    v_smfmac_f32_16x16x64_bf16 v[136:139], a[20:23], v[64:71], v249 abid:1
    s_nop 0
    ds_read_b64 v[56:57], v253 offset:5696
    ds_read_b64 v[58:59], v253 offset:5704
    ds_read_b64 v[60:61], v252 offset:5984
    ds_read_b64 v[62:63], v252 offset:5992
    buffer_load_dwordx4 v24, s[28:31], s92 offen offset:1024 lds
    s_waitcnt lgkmcnt(8)
    v_smfmac_f32_16x16x64_bf16 v[140:143], a[28:31], v[72:79], v249 abid:1
    s_nop 0
    ds_read_b64 v[64:65], v253 offset:6720
    ds_read_b64 v[66:67], v253 offset:6728
    ds_read_b64 v[68:69], v252 offset:7008
    ds_read_b64 v[70:71], v252 offset:7016
    s_waitcnt lgkmcnt(8)
    v_smfmac_f32_16x16x64_bf16 v[144:147], a[36:39], v[48:55], v249 abid:1
    s_nop 0
    ds_read_b64 v[72:73], v253 offset:7744
    ds_read_b64 v[74:75], v253 offset:7752
    ds_read_b64 v[76:77], v252 offset:8032
    ds_read_b64 v[78:79], v252 offset:8040
    buffer_load_dwordx4 v24, s[28:31], s93 offen offset:2048 lds
    s_waitcnt lgkmcnt(8)
    v_smfmac_f32_16x16x64_bf16 v[148:151], a[44:47], v[56:63], v249 abid:1
    s_nop 0
    ds_read_b64 v[48:49], v241 offset:8800
    ds_read_b64 v[50:51], v241 offset:8808
    ds_read_b64 v[52:53], v240 offset:9088
    ds_read_b64 v[54:55], v240 offset:9096
    s_waitcnt lgkmcnt(8)
    v_smfmac_f32_16x16x64_bf16 v[152:155], a[52:55], v[64:71], v249 abid:1
    s_nop 0
    ds_read_b64 v[56:57], v241 offset:9824
    ds_read_b64 v[58:59], v241 offset:9832
    ds_read_b64 v[60:61], v240 offset:10112
    ds_read_b64 v[62:63], v240 offset:10120
    buffer_load_dwordx4 v24, s[28:31], s94 offen offset:3072 lds
    s_waitcnt lgkmcnt(8)
    v_smfmac_f32_16x16x64_bf16 v[156:159], a[60:63], v[72:79], v249 abid:1
    s_nop 0
    ds_read_b64 v[64:65], v241 offset:10848
    ds_read_b64 v[66:67], v241 offset:10856
    ds_read_b64 v[68:69], v240 offset:11136
    ds_read_b64 v[70:71], v240 offset:11144
    s_waitcnt lgkmcnt(8)
    v_smfmac_f32_16x16x64_bf16 v[160:163], a[68:71], v[48:55], v249 abid:1
    s_add_u32 m0, s76, 102912
    ds_read_b64 v[72:73], v241 offset:11872
    ds_read_b64 v[74:75], v241 offset:11880
    ds_read_b64 v[76:77], v240 offset:12160
    ds_read_b64 v[78:79], v240 offset:12168
    buffer_load_dwordx4 v24, s[28:31], s95 offen offset:0 lds
    s_waitcnt lgkmcnt(8)
    v_smfmac_f32_16x16x64_bf16 v[164:167], a[76:79], v[56:63], v249 abid:1
    s_nop 0
    ds_read_b64 v[48:49], v241 offset:12896
    ds_read_b64 v[50:51], v241 offset:12904
    ds_read_b64 v[52:53], v240 offset:13184
    ds_read_b64 v[54:55], v240 offset:13192
    s_waitcnt lgkmcnt(8)
    v_smfmac_f32_16x16x64_bf16 v[168:171], a[84:87], v[64:71], v249 abid:1
    s_nop 0
    ds_read_b64 v[56:57], v241 offset:13920
    ds_read_b64 v[58:59], v241 offset:13928
    ds_read_b64 v[60:61], v240 offset:14208
    ds_read_b64 v[62:63], v240 offset:14216
    buffer_load_dwordx4 v24, s[28:31], s96 offen offset:1024 lds
    v_add_u32 v24, 128, v24
    s_waitcnt lgkmcnt(8)
    v_smfmac_f32_16x16x64_bf16 v[172:175], a[92:95], v[72:79], v249 abid:1
    s_nop 0
    ds_read_b64 v[64:65], v241 offset:14944
    ds_read_b64 v[66:67], v241 offset:14952
    ds_read_b64 v[68:69], v240 offset:15232
    ds_read_b64 v[70:71], v240 offset:15240
    s_waitcnt lgkmcnt(8)
    v_smfmac_f32_16x16x64_bf16 v[176:179], a[100:103], v[48:55], v249 abid:1
    s_add_u32 m0, s76, 123392
    ds_read_b64 v[72:73], v241 offset:15968
    ds_read_b64 v[74:75], v241 offset:15976
    ds_read_b64 v[76:77], v240 offset:16256
    ds_read_b64 v[78:79], v240 offset:16264
    buffer_load_dwordx4 v24, s[28:31], 0 offen offset:0 lds
    s_waitcnt lgkmcnt(8)
    v_smfmac_f32_16x16x64_bf16 v[180:183], a[108:111], v[56:63], v249 abid:1
    s_nop 0
    ds_read_b64 v[48:49], v243 offset:17024
    ds_read_b64 v[50:51], v243 offset:17032
    ds_read_b64 v[52:53], v242 offset:17312
    ds_read_b64 v[54:55], v242 offset:17320
    s_waitcnt lgkmcnt(8)
    v_smfmac_f32_16x16x64_bf16 v[184:187], a[116:119], v[64:71], v249 abid:1
    s_nop 0
    ds_read_b64 v[56:57], v243 offset:18048
    ds_read_b64 v[58:59], v243 offset:18056
    ds_read_b64 v[60:61], v242 offset:18336
    ds_read_b64 v[62:63], v242 offset:18344
    buffer_load_dwordx4 v24, s[28:31], s92 offen offset:1024 lds
    s_waitcnt lgkmcnt(8)
    v_smfmac_f32_16x16x64_bf16 v[188:191], a[124:127], v[72:79], v249 abid:1
    s_nop 0
    ds_read_b64 v[64:65], v243 offset:19072
    ds_read_b64 v[66:67], v243 offset:19080
    ds_read_b64 v[68:69], v242 offset:19360
    ds_read_b64 v[70:71], v242 offset:19368
    s_waitcnt lgkmcnt(8)
    v_smfmac_f32_16x16x64_bf16 v[192:195], a[132:135], v[48:55], v249 abid:1
    s_nop 0
    ds_read_b64 v[72:73], v243 offset:20096
    ds_read_b64 v[74:75], v243 offset:20104
    ds_read_b64 v[76:77], v242 offset:20384
    ds_read_b64 v[78:79], v242 offset:20392
    buffer_load_dwordx4 v24, s[28:31], s93 offen offset:2048 lds
    s_waitcnt lgkmcnt(8)
    v_smfmac_f32_16x16x64_bf16 v[196:199], a[140:143], v[56:63], v249 abid:1
    s_nop 0
    ds_read_b64 v[48:49], v243 offset:21120
    ds_read_b64 v[50:51], v243 offset:21128
    ds_read_b64 v[52:53], v242 offset:21408
    ds_read_b64 v[54:55], v242 offset:21416
    s_waitcnt lgkmcnt(8)
    v_smfmac_f32_16x16x64_bf16 v[200:203], a[148:151], v[64:71], v249 abid:1
    s_nop 0
    ds_read_b64 v[56:57], v243 offset:22144
    ds_read_b64 v[58:59], v243 offset:22152
    ds_read_b64 v[60:61], v242 offset:22432
    ds_read_b64 v[62:63], v242 offset:22440
    buffer_load_dwordx4 v24, s[28:31], s94 offen offset:3072 lds
    s_waitcnt lgkmcnt(8)
    v_smfmac_f32_16x16x64_bf16 v[204:207], a[156:159], v[72:79], v249 abid:1
    s_nop 0
    ds_read_b64 v[64:65], v243 offset:23168
    ds_read_b64 v[66:67], v243 offset:23176
    ds_read_b64 v[68:69], v242 offset:23456
    ds_read_b64 v[70:71], v242 offset:23464
    s_waitcnt lgkmcnt(8)
    v_smfmac_f32_16x16x64_bf16 v[208:211], a[164:167], v[48:55], v249 abid:1
    s_add_u32 m0, s76, 127488
    ds_read_b64 v[72:73], v243 offset:24192
    ds_read_b64 v[74:75], v243 offset:24200
    ds_read_b64 v[76:77], v242 offset:24480
    ds_read_b64 v[78:79], v242 offset:24488
    buffer_load_dwordx4 v24, s[28:31], s95 offen offset:0 lds
    s_waitcnt lgkmcnt(8)
    v_smfmac_f32_16x16x64_bf16 v[212:215], a[172:175], v[56:63], v249 abid:1
    s_waitcnt lgkmcnt(4)
    v_smfmac_f32_16x16x64_bf16 v[216:219], a[180:183], v[64:71], v249 abid:1
    buffer_load_dwordx4 v24, s[28:31], s96 offen offset:1024 lds
    v_add_u32 v24, 128, v24
    s_waitcnt lgkmcnt(0)
    v_smfmac_f32_16x16x64_bf16 v[220:223], a[188:191], v[72:79], v249 abid:1
    v_pk_mul_f32 v[52:53], v[128:129], v[128:129]
    v_pk_mul_f32 v[54:55], v[130:131], v[130:131]
    v_pk_add_f32 v[48:49], v[128:129], v[132:133]
    v_pk_fma_f32 v[52:53], v[132:133], v[132:133], v[52:53]
    v_pk_add_f32 v[50:51], v[130:131], v[134:135]
    v_pk_fma_f32 v[54:55], v[134:135], v[134:135], v[54:55]
    v_pk_add_f32 v[48:49], v[48:49], v[136:137]
    v_pk_fma_f32 v[52:53], v[136:137], v[136:137], v[52:53]
    v_pk_add_f32 v[50:51], v[50:51], v[138:139]
    v_pk_fma_f32 v[54:55], v[138:139], v[138:139], v[54:55]
    v_pk_add_f32 v[48:49], v[48:49], v[140:141]
    v_pk_fma_f32 v[52:53], v[140:141], v[140:141], v[52:53]
    v_pk_add_f32 v[50:51], v[50:51], v[142:143]
    v_pk_fma_f32 v[54:55], v[142:143], v[142:143], v[54:55]
    v_pk_add_f32 v[48:49], v[48:49], v[144:145]
    v_pk_fma_f32 v[52:53], v[144:145], v[144:145], v[52:53]
    s_mov_b32 s88, 0x3c2aaaab
    v_pk_add_f32 v[50:51], v[50:51], v[146:147]
    v_pk_fma_f32 v[54:55], v[146:147], v[146:147], v[54:55]
    v_pk_add_f32 v[48:49], v[48:49], v[148:149]
    v_pk_fma_f32 v[52:53], v[148:149], v[148:149], v[52:53]
    v_pk_add_f32 v[50:51], v[50:51], v[150:151]
    v_pk_fma_f32 v[54:55], v[150:151], v[150:151], v[54:55]
    v_pk_add_f32 v[48:49], v[48:49], v[152:153]
    v_pk_fma_f32 v[52:53], v[152:153], v[152:153], v[52:53]
    v_pk_add_f32 v[50:51], v[50:51], v[154:155]
    v_pk_fma_f32 v[54:55], v[154:155], v[154:155], v[54:55]
    v_pk_add_f32 v[48:49], v[48:49], v[156:157]
    v_pk_fma_f32 v[52:53], v[156:157], v[156:157], v[52:53]
    v_pk_add_f32 v[50:51], v[50:51], v[158:159]
    v_pk_fma_f32 v[54:55], v[158:159], v[158:159], v[54:55]
    v_pk_add_f32 v[48:49], v[48:49], v[160:161]
    v_pk_fma_f32 v[52:53], v[160:161], v[160:161], v[52:53]
    s_mov_b32 s89, 0x3c2aaaab
    v_pk_add_f32 v[50:51], v[50:51], v[162:163]
    v_pk_fma_f32 v[54:55], v[162:163], v[162:163], v[54:55]
    v_pk_add_f32 v[48:49], v[48:49], v[164:165]
    v_pk_fma_f32 v[52:53], v[164:165], v[164:165], v[52:53]
    v_pk_add_f32 v[50:51], v[50:51], v[166:167]
    v_pk_fma_f32 v[54:55], v[166:167], v[166:167], v[54:55]
    v_pk_add_f32 v[48:49], v[48:49], v[168:169]
    v_pk_fma_f32 v[52:53], v[168:169], v[168:169], v[52:53]
    v_pk_add_f32 v[50:51], v[50:51], v[170:171]
    v_pk_fma_f32 v[54:55], v[170:171], v[170:171], v[54:55]
    v_pk_add_f32 v[48:49], v[48:49], v[172:173]
    v_pk_fma_f32 v[52:53], v[172:173], v[172:173], v[52:53]
    v_pk_add_f32 v[50:51], v[50:51], v[174:175]
    v_pk_fma_f32 v[54:55], v[174:175], v[174:175], v[54:55]
    v_pk_add_f32 v[48:49], v[48:49], v[176:177]
    s_mov_b32 s90, 0x3727c5ac
    v_pk_fma_f32 v[52:53], v[176:177], v[176:177], v[52:53]
    v_pk_add_f32 v[50:51], v[50:51], v[178:179]
    v_pk_fma_f32 v[54:55], v[178:179], v[178:179], v[54:55]
    v_pk_add_f32 v[48:49], v[48:49], v[180:181]
    v_pk_fma_f32 v[52:53], v[180:181], v[180:181], v[52:53]
    v_pk_add_f32 v[50:51], v[50:51], v[182:183]
    v_pk_fma_f32 v[54:55], v[182:183], v[182:183], v[54:55]
    v_pk_add_f32 v[48:49], v[48:49], v[184:185]
    v_pk_fma_f32 v[52:53], v[184:185], v[184:185], v[52:53]
    v_pk_add_f32 v[50:51], v[50:51], v[186:187]
    v_pk_fma_f32 v[54:55], v[186:187], v[186:187], v[54:55]
    v_pk_add_f32 v[48:49], v[48:49], v[188:189]
    v_pk_fma_f32 v[52:53], v[188:189], v[188:189], v[52:53]
    v_pk_add_f32 v[50:51], v[50:51], v[190:191]
    v_pk_fma_f32 v[54:55], v[190:191], v[190:191], v[54:55]
    v_pk_add_f32 v[48:49], v[48:49], v[192:193]
    s_mov_b32 s91, 0x3727c5ac
    v_pk_fma_f32 v[52:53], v[192:193], v[192:193], v[52:53]
    v_pk_add_f32 v[50:51], v[50:51], v[194:195]
    v_pk_fma_f32 v[54:55], v[194:195], v[194:195], v[54:55]
    v_pk_add_f32 v[48:49], v[48:49], v[196:197]
    v_pk_fma_f32 v[52:53], v[196:197], v[196:197], v[52:53]
    v_pk_add_f32 v[50:51], v[50:51], v[198:199]
    v_pk_fma_f32 v[54:55], v[198:199], v[198:199], v[54:55]
    v_pk_add_f32 v[48:49], v[48:49], v[200:201]
    v_pk_fma_f32 v[52:53], v[200:201], v[200:201], v[52:53]
    v_pk_add_f32 v[50:51], v[50:51], v[202:203]
    v_pk_fma_f32 v[54:55], v[202:203], v[202:203], v[54:55]
    v_pk_add_f32 v[48:49], v[48:49], v[204:205]
    v_pk_fma_f32 v[52:53], v[204:205], v[204:205], v[52:53]
    v_pk_add_f32 v[50:51], v[50:51], v[206:207]
    v_pk_fma_f32 v[54:55], v[206:207], v[206:207], v[54:55]
    v_pk_add_f32 v[48:49], v[48:49], v[208:209]
    s_mov_b32 s84, 0x3eeff558
    v_pk_fma_f32 v[52:53], v[208:209], v[208:209], v[52:53]
    v_pk_add_f32 v[50:51], v[50:51], v[210:211]
    v_pk_fma_f32 v[54:55], v[210:211], v[210:211], v[54:55]
    v_pk_add_f32 v[48:49], v[48:49], v[212:213]
    v_pk_fma_f32 v[52:53], v[212:213], v[212:213], v[52:53]
    v_pk_add_f32 v[50:51], v[50:51], v[214:215]
    v_pk_fma_f32 v[54:55], v[214:215], v[214:215], v[54:55]
    v_pk_add_f32 v[48:49], v[48:49], v[216:217]
    v_pk_fma_f32 v[52:53], v[216:217], v[216:217], v[52:53]
    v_pk_add_f32 v[50:51], v[50:51], v[218:219]
    v_pk_fma_f32 v[54:55], v[218:219], v[218:219], v[54:55]
    v_pk_add_f32 v[48:49], v[48:49], v[220:221]
    v_pk_fma_f32 v[52:53], v[220:221], v[220:221], v[52:53]
    v_pk_add_f32 v[50:51], v[50:51], v[222:223]
    v_pk_fma_f32 v[54:55], v[222:223], v[222:223], v[54:55]
    s_mov_b32 s85, 0x3eeff558
    ds_write_b128 v32, v[48:51]
    ds_write_b128 v32, v[52:55] offset:1024
    v_lshrrev_b32 v233, 2, v251
    v_and_b32 v235, 3, v251
    v_add_u32 v234, 6, v233
    v_subrev_u32 v238, 12, v234
    s_lshl_b32 s26, s49, 6
    s_add_u32 s26, s26, 65536
    s_lshl1_add_u32 s27, s97, s51
    s_add_u32 s27, s27, 262656
    s_mul_i32 s38, s49, 288
    s_add_u32 s38, s38, 157696
    s_lshl1_add_u32 s77, s76, 49152
    s_add_u32 s79, s76, 125440
    s_xor_b32 s80, s48, 1
    s_mul_i32 s80, s80, 6144
    s_lshl1_add_u32 s78, s80, 49152
    s_add_u32 s80, s80, 125440
    s_sub_u32 s81, s50, s48
    s_mul_i32 s81, s81, 6656
    s_add_u32 s81, s81, 4294917632
    s_mul_i32 s82, s49, 3328
    s_add_u32 s82, s82, s81
    s_lshr_b32 s83, s76, 1
    s_add_u32 s83, s83, 65536
    v_min_u32 v234, v234, v238
    v_lshl_add_u32 v235, v235, 4, s26
    v_lshrrev_b32 v237, 2, v233
    v_lshl_add_u32 v237, v237, 10, v235
    v_and_b32 v238, 3, v233
    v_lshl_add_u32 v26, v238, 7, v237
    v_lshrrev_b32 v237, 2, v234
    v_lshl_add_u32 v237, v237, 10, v235
    v_and_b32_e64 v238, 3, v234
    v_lshl_add_u32 v27, v238, 7, v237
    v_lshl_add_u32 v28, v251, 1, s27
    v_lshl_add_u32 v29, v251, 2, s38
    s_waitcnt vmcnt(6) lgkmcnt(0)
    s_barrier
    ds_read_b128 v[64:67], v33 offset:0
    ds_read_b128 v[68:71], v33 offset:1024
    ds_read_b128 v[72:75], v33 offset:2048
    ds_read_b128 v[76:79], v33 offset:3072
    ds_read_b128 v[80:83], v33 offset:4096
    ds_read_b128 v[84:87], v33 offset:5120
    ds_read_b128 v[88:91], v33 offset:6144
    ds_read_b128 v[92:95], v33 offset:7168
    ds_read_b64_tr_b16 a[0:1], v40 offset:25088
    ds_read_b64_tr_b16 a[2:3], v40 offset:25600
    ds_read_b64_tr_b16 a[4:5], v40 offset:27136
    ds_read_b64_tr_b16 a[6:7], v40 offset:27648
    s_add_u32 m0, s76, 49152
    s_nop 0
    buffer_load_dwordx4 v25, s[32:35], 0 offen offset:0 lds
    ds_read_b64_tr_b16 a[8:9], v40 offset:29184
    ds_read_b64_tr_b16 a[10:11], v40 offset:29696
    ds_read_b64_tr_b16 a[12:13], v40 offset:31232
    ds_read_b64_tr_b16 a[14:15], v40 offset:31744
    buffer_load_dwordx4 v25, s[32:35], 0 offen offset:1024 lds
    ds_read_b64_tr_b16 a[16:17], v40 offset:33280
    ds_read_b64_tr_b16 a[18:19], v40 offset:33792
    ds_read_b64_tr_b16 a[20:21], v40 offset:35328
    ds_read_b64_tr_b16 a[22:23], v40 offset:35840
    buffer_load_dwordx4 v25, s[32:35], 0 offen offset:2048 lds
    ds_write_b128 v34, v[36:39] offset:3136
    s_waitcnt lgkmcnt(13)
    v_pk_add_f32 v[64:65], v[64:65], v[72:73]
    v_pk_add_f32 v[66:67], v[66:67], v[74:75]
    v_pk_add_f32 v[68:69], v[68:69], v[76:77]
    v_pk_add_f32 v[70:71], v[70:71], v[78:79]
    v_pk_add_f32 v[80:81], v[80:81], v[88:89]
    v_pk_add_f32 v[82:83], v[82:83], v[90:91]
    v_pk_add_f32 v[84:85], v[84:85], v[92:93]
    v_pk_add_f32 v[86:87], v[86:87], v[94:95]
    v_pk_add_f32 v[64:65], v[64:65], v[80:81]
    v_pk_add_f32 v[66:67], v[66:67], v[82:83]
    v_pk_add_f32 v[68:69], v[68:69], v[84:85]
    v_pk_add_f32 v[70:71], v[70:71], v[86:87]
    v_pk_mul_f32 v[64:65], v[64:65], s[88:89]
    v_pk_mul_f32 v[66:67], v[66:67], s[88:89]
    v_pk_fma_f32 v[72:73], v[64:65], v[64:65], s[90:91] neg_lo:[1,0,0] neg_hi:[1,0,0]
    v_pk_fma_f32 v[74:75], v[66:67], v[66:67], s[90:91] neg_lo:[1,0,0] neg_hi:[1,0,0]
    v_pk_fma_f32 v[68:69], v[68:69], s[88:89], v[72:73]
    v_pk_fma_f32 v[70:71], v[70:71], s[88:89], v[74:75]
    v_max_f32 v68, s90, v68
    v_max_f32 v69, s90, v69
    v_max_f32 v70, s90, v70
    v_max_f32 v71, s90, v71
    v_rsq_f32 v72, v68
    v_rsq_f32 v73, v69
    v_rsq_f32 v74, v70
    v_rsq_f32 v75, v71
    v_pk_mul_f32 v[72:73], v[72:73], s[84:85]
    v_pk_mul_f32 v[74:75], v[74:75], s[84:85]
    v_pk_mul_f32 v[76:77], v[64:65], v[72:73] neg_lo:[1,0] neg_hi:[1,0]
    v_pk_mul_f32 v[78:79], v[66:67], v[74:75] neg_lo:[1,0] neg_hi:[1,0]
    ds_read_b128 v[96:99], v3 offset:0
    ds_read_b128 v[100:103], v3 offset:32
    ds_read_b128 v[104:107], v3 offset:64
    ds_read_b128 v[108:111], v3 offset:96
    v_pk_fma_f32 v[128:129], v[128:129], v[72:73], v[76:77]
    v_pk_fma_f32 v[132:133], v[132:133], v[72:73], v[76:77]
    v_pk_fma_f32 v[136:137], v[136:137], v[72:73], v[76:77]
    v_pk_fma_f32 v[140:141], v[140:141], v[72:73], v[76:77]
    v_pk_fma_f32 v[144:145], v[144:145], v[72:73], v[76:77]
    v_pk_fma_f32 v[148:149], v[148:149], v[72:73], v[76:77]
    v_pk_fma_f32 v[152:153], v[152:153], v[72:73], v[76:77]
    v_pk_fma_f32 v[156:157], v[156:157], v[72:73], v[76:77]
    v_cvt_pk_bf16_f32 v224, v128, v132
    v_cvt_pk_bf16_f32 v225, v136, v140
    v_cvt_pk_bf16_f32 v226, v144, v148
    v_cvt_pk_bf16_f32 v227, v152, v156
    ds_write_b128 v250, v[224:227] offset:0
    v_pk_fma_f32 v[160:161], v[160:161], v[72:73], v[76:77]
    v_pk_fma_f32 v[164:165], v[164:165], v[72:73], v[76:77]
    v_pk_fma_f32 v[168:169], v[168:169], v[72:73], v[76:77]
    v_pk_fma_f32 v[172:173], v[172:173], v[72:73], v[76:77]
    v_cvt_pk_bf16_f32 v228, v129, v133
    v_cvt_pk_bf16_f32 v229, v137, v141
    v_cvt_pk_bf16_f32 v230, v145, v149
    v_cvt_pk_bf16_f32 v231, v153, v157
    ds_write_b128 v245, v[228:231] offset:0
    v_pk_fma_f32 v[176:177], v[176:177], v[72:73], v[76:77]
    v_pk_fma_f32 v[180:181], v[180:181], v[72:73], v[76:77]
    v_pk_fma_f32 v[184:185], v[184:185], v[72:73], v[76:77]
    v_pk_fma_f32 v[188:189], v[188:189], v[72:73], v[76:77]
    v_cvt_pk_bf16_f32 v224, v160, v164
    v_cvt_pk_bf16_f32 v225, v168, v172
    v_cvt_pk_bf16_f32 v226, v176, v180
    v_cvt_pk_bf16_f32 v227, v184, v188
    ds_write_b128 v250, v[224:227] offset:3152
    v_pk_fma_f32 v[192:193], v[192:193], v[72:73], v[76:77]
    v_pk_fma_f32 v[196:197], v[196:197], v[72:73], v[76:77]
    v_pk_fma_f32 v[200:201], v[200:201], v[72:73], v[76:77]
    v_pk_fma_f32 v[204:205], v[204:205], v[72:73], v[76:77]
    v_cvt_pk_bf16_f32 v228, v161, v165
    v_cvt_pk_bf16_f32 v229, v169, v173
    v_cvt_pk_bf16_f32 v230, v177, v181
    v_cvt_pk_bf16_f32 v231, v185, v189
    ds_write_b128 v245, v[228:231] offset:3152
    v_pk_fma_f32 v[208:209], v[208:209], v[72:73], v[76:77]
    v_pk_fma_f32 v[212:213], v[212:213], v[72:73], v[76:77]
    v_pk_fma_f32 v[216:217], v[216:217], v[72:73], v[76:77]
    v_pk_fma_f32 v[220:221], v[220:221], v[72:73], v[76:77]
    v_cvt_pk_bf16_f32 v224, v192, v196
    v_cvt_pk_bf16_f32 v225, v200, v204
    v_cvt_pk_bf16_f32 v226, v208, v212
    v_cvt_pk_bf16_f32 v227, v216, v220
    ds_write_b128 v250, v[224:227] offset:6304
    v_pk_fma_f32 v[130:131], v[130:131], v[74:75], v[78:79]
    v_pk_fma_f32 v[134:135], v[134:135], v[74:75], v[78:79]
    v_pk_fma_f32 v[138:139], v[138:139], v[74:75], v[78:79]
    v_pk_fma_f32 v[142:143], v[142:143], v[74:75], v[78:79]
    v_cvt_pk_bf16_f32 v228, v193, v197
    v_cvt_pk_bf16_f32 v229, v201, v205
    v_cvt_pk_bf16_f32 v230, v209, v213
    v_cvt_pk_bf16_f32 v231, v217, v221
    ds_write_b128 v245, v[228:231] offset:6304
    v_pk_fma_f32 v[146:147], v[146:147], v[74:75], v[78:79]
    v_pk_fma_f32 v[150:151], v[150:151], v[74:75], v[78:79]
    v_pk_fma_f32 v[154:155], v[154:155], v[74:75], v[78:79]
    v_pk_fma_f32 v[158:159], v[158:159], v[74:75], v[78:79]
    v_cvt_pk_bf16_f32 v224, v130, v134
    v_cvt_pk_bf16_f32 v225, v138, v142
    v_cvt_pk_bf16_f32 v226, v146, v150
    v_cvt_pk_bf16_f32 v227, v154, v158
    ds_write_b128 v15, v[224:227] offset:0
    v_pk_fma_f32 v[162:163], v[162:163], v[74:75], v[78:79]
    v_pk_fma_f32 v[166:167], v[166:167], v[74:75], v[78:79]
    v_pk_fma_f32 v[170:171], v[170:171], v[74:75], v[78:79]
    v_pk_fma_f32 v[174:175], v[174:175], v[74:75], v[78:79]
    v_cvt_pk_bf16_f32 v228, v131, v135
    v_cvt_pk_bf16_f32 v229, v139, v143
    v_cvt_pk_bf16_f32 v230, v147, v151
    v_cvt_pk_bf16_f32 v231, v155, v159
    ds_write_b128 v246, v[228:231] offset:0
    v_pk_fma_f32 v[178:179], v[178:179], v[74:75], v[78:79]
    v_pk_fma_f32 v[182:183], v[182:183], v[74:75], v[78:79]
    v_pk_fma_f32 v[186:187], v[186:187], v[74:75], v[78:79]
    v_pk_fma_f32 v[190:191], v[190:191], v[74:75], v[78:79]
    v_cvt_pk_bf16_f32 v224, v162, v166
    v_cvt_pk_bf16_f32 v225, v170, v174
    v_cvt_pk_bf16_f32 v226, v178, v182
    v_cvt_pk_bf16_f32 v227, v186, v190
    ds_write_b128 v15, v[224:227] offset:3152
    v_pk_fma_f32 v[194:195], v[194:195], v[74:75], v[78:79]
    v_pk_fma_f32 v[198:199], v[198:199], v[74:75], v[78:79]
    v_pk_fma_f32 v[202:203], v[202:203], v[74:75], v[78:79]
    v_pk_fma_f32 v[206:207], v[206:207], v[74:75], v[78:79]
    v_cvt_pk_bf16_f32 v228, v163, v167
    v_cvt_pk_bf16_f32 v229, v171, v175
    v_cvt_pk_bf16_f32 v230, v179, v183
    v_cvt_pk_bf16_f32 v231, v187, v191
    ds_write_b128 v246, v[228:231] offset:3152
    v_pk_fma_f32 v[210:211], v[210:211], v[74:75], v[78:79]
    v_pk_fma_f32 v[214:215], v[214:215], v[74:75], v[78:79]
    v_pk_fma_f32 v[218:219], v[218:219], v[74:75], v[78:79]
    v_pk_fma_f32 v[222:223], v[222:223], v[74:75], v[78:79]
    v_cvt_pk_bf16_f32 v224, v194, v198
    v_cvt_pk_bf16_f32 v225, v202, v206
    v_cvt_pk_bf16_f32 v226, v210, v214
    v_cvt_pk_bf16_f32 v227, v218, v222
    ds_write_b128 v15, v[224:227] offset:6304
    v_cvt_pk_bf16_f32 v228, v195, v199
    v_cvt_pk_bf16_f32 v229, v203, v207
    v_cvt_pk_bf16_f32 v230, v211, v215
    v_cvt_pk_bf16_f32 v231, v219, v223
    ds_write_b128 v246, v[228:231] offset:6304
    s_mov_b64 exec, 0
    s_cmp_eq_u32 s48, 0
    s_cbranch_scc1 L_pad4
    s_cmp_eq_u32 s48, 1
    s_cbranch_scc1 L_pad5
L_back:
    s_mov_b64 exec, -1
    s_waitcnt vmcnt(3) lgkmcnt(0)
    s_barrier
    ds_read_b128 v[72:75], v13 offset:0
    ds_read_b128 v[76:79], v13 offset:6304
    ds_read_b128 v[80:83], v13 offset:12608
    ds_read_b128 v[84:87], v13 offset:18912
    ds_read_b128 v[88:91], v13 offset:25216
    ds_read_b128 v[92:95], v13 offset:31520
    buffer_load_dwordx4 v25, s[32:35], 0 offen offset:3072 lds
    ds_read_b64_tr_b16 a[24:25], v41 offset:25088
    ds_read_b64_tr_b16 a[26:27], v41 offset:25600
    ds_read_b64_tr_b16 a[28:29], v41 offset:27136
    ds_read_b64_tr_b16 a[30:31], v41 offset:27648
    ds_read_b64_tr_b16 a[32:33], v41 offset:29184
    s_add_u32 m0, s76, 53248
    s_nop 0
    buffer_load_dwordx4 v25, s[32:35], s99 offen offset:0 lds
    s_waitcnt lgkmcnt(9)
    v_mfma_f32_32x32x16_bf16 v[128:143], a[0:3], v[72:75], v[96:111]
    ds_read_b64_tr_b16 a[34:35], v41 offset:29696
    ds_read_b64_tr_b16 a[36:37], v41 offset:31232
    ds_read_b64_tr_b16 a[38:39], v41 offset:31744
    ds_read_b64_tr_b16 a[40:41], v41 offset:33280
    buffer_load_dwordx4 v25, s[32:35], s99 offen offset:1024 lds
    v_add_u32 v25, 12288, v25
    v_mfma_f32_32x32x16_bf16 v[128:143], a[4:7], v[76:79], v[128:143]
    s_waitcnt lgkmcnt(9)
    ds_read_b64_tr_b16 a[42:43], v41 offset:33792
    ds_read_b64_tr_b16 a[44:45], v41 offset:35328
    ds_read_b64_tr_b16 a[46:47], v41 offset:35840
    v_mfma_f32_32x32x16_bf16 v[128:143], a[8:11], v[80:83], v[128:143]
    ds_read_b128 v[96:99], v4 offset:0
    ds_read_b128 v[100:103], v4 offset:32
    ds_read_b128 v[104:107], v4 offset:64
    ds_read_b128 v[108:111], v4 offset:96
    s_add_u32 m0, s76, 73728
    s_nop 0
    buffer_load_dwordx4 v24, s[28:31], 0 offen offset:0 lds
    v_mfma_f32_32x32x16_bf16 v[128:143], a[12:15], v[84:87], v[128:143]
    ds_read_b128 v[176:179], v5 offset:0
    ds_read_b128 v[180:183], v5 offset:16
    ds_read_b128 v[184:187], v5 offset:32
    ds_read_b128 v[188:191], v5 offset:48
    ds_read_b128 v[192:195], v5 offset:64
    v_mfma_f32_32x32x16_bf16 v[128:143], a[16:19], v[88:91], v[128:143]
    buffer_load_dwordx4 v24, s[28:31], s92 offen offset:1024 lds
    ds_read_b128 v[196:199], v5 offset:80
    ds_read_b128 v[200:203], v5 offset:96
    ds_read_b128 v[204:207], v5 offset:112
    ds_read_b128 v[208:211], v5 offset:128
    ds_read_b128 v[212:215], v5 offset:144
    v_mfma_f32_32x32x16_bf16 v[128:143], a[20:23], v[92:95], v[128:143]
    ds_read_b128 v[216:219], v5 offset:160
    ds_read_b128 v[220:223], v5 offset:176
    buffer_load_dwordx4 v24, s[28:31], s93 offen offset:2048 lds
    s_nop 8
    v_pk_fma_f32 v[112:113], v[128:129], v[128:129], s[58:59] neg_lo:[1,0,0] neg_hi:[1,0,0]
    v_pk_fma_f32 v[114:115], v[130:131], v[130:131], s[58:59] neg_lo:[1,0,0] neg_hi:[1,0,0]
    v_pk_fma_f32 v[116:117], v[132:133], v[132:133], s[58:59] neg_lo:[1,0,0] neg_hi:[1,0,0]
    v_pk_fma_f32 v[118:119], v[134:135], v[134:135], s[58:59] neg_lo:[1,0,0] neg_hi:[1,0,0]
    v_pk_fma_f32 v[120:121], v[136:137], v[136:137], s[58:59] neg_lo:[1,0,0] neg_hi:[1,0,0]
    v_pk_fma_f32 v[122:123], v[138:139], v[138:139], s[58:59] neg_lo:[1,0,0] neg_hi:[1,0,0]
    v_pk_fma_f32 v[124:125], v[140:141], v[140:141], s[58:59] neg_lo:[1,0,0] neg_hi:[1,0,0]
    v_pk_fma_f32 v[126:127], v[142:143], v[142:143], s[58:59] neg_lo:[1,0,0] neg_hi:[1,0,0]
    v_pk_mul_f32 v[112:113], v[112:113], v[128:129]
    v_pk_mul_f32 v[114:115], v[114:115], v[130:131]
    v_pk_mul_f32 v[116:117], v[116:117], v[132:133]
L_pad2:
    s_cbranch_execz L_go
    v_pk_mul_f32 v[118:119], v[118:119], v[134:135]
    v_pk_mul_f32 v[120:121], v[120:121], v[136:137]
    v_pk_mul_f32 v[122:123], v[122:123], v[138:139]
    v_pk_mul_f32 v[124:125], v[124:125], v[140:141]
    v_pk_mul_f32 v[126:127], v[126:127], v[142:143]
    s_waitcnt lgkmcnt(12)
    v_mfma_f32_32x32x16_bf16 v[144:159], a[24:27], v[72:75], v[96:111]
    ds_read_b64_tr_b16 a[48:49], v40 offset:49664
    ds_read_b64_tr_b16 a[50:51], v40 offset:50176
    ds_read_b64_tr_b16 a[52:53], v40 offset:51712
    ds_read_b64_tr_b16 a[54:55], v40 offset:52224
    ds_read_b64_tr_b16 a[56:57], v40 offset:53760
    buffer_load_dwordx4 v24, s[28:31], s94 offen offset:3072 lds
    v_exp_f32 v112, v112
    v_mfma_f32_32x32x16_bf16 v[144:159], a[28:31], v[76:79], v[144:159]
    ds_read_b64_tr_b16 a[58:59], v40 offset:54272
    ds_read_b64_tr_b16 a[60:61], v40 offset:55808
    ds_read_b64_tr_b16 a[62:63], v40 offset:56320
    ds_read_b64_tr_b16 a[64:65], v40 offset:57856
    ds_read_b64_tr_b16 a[66:67], v40 offset:58368
    s_add_u32 m0, s76, 77824
    s_nop 0
    buffer_load_dwordx4 v24, s[28:31], s95 offen offset:0 lds
    v_exp_f32 v113, v113
    v_mfma_f32_32x32x16_bf16 v[144:159], a[32:35], v[80:83], v[144:159]
    ds_read_b64_tr_b16 a[68:69], v40 offset:59904
    ds_read_b64_tr_b16 a[70:71], v40 offset:60416
    ds_read_b64_tr_b16 a[72:73], v41 offset:49664
    ds_read_b64_tr_b16 a[74:75], v41 offset:50176
    ds_read_b64_tr_b16 a[76:77], v41 offset:51712
    buffer_load_dwordx4 v24, s[28:31], s96 offen offset:1024 lds
    v_exp_f32_e64 v114, v114
    v_mfma_f32_32x32x16_bf16 v[144:159], a[36:39], v[84:87], v[144:159]
    ds_read_b64_tr_b16 a[78:79], v41 offset:52224
    ds_read_b64_tr_b16 a[80:81], v41 offset:53760
    ds_read_b64_tr_b16 a[82:83], v41 offset:54272
    ds_read_b64_tr_b16 a[84:85], v41 offset:55808
    ds_read_b64_tr_b16 a[86:87], v41 offset:56320
    v_exp_f32_e64 v115, v115
    v_mfma_f32_32x32x16_bf16 v[144:159], a[40:43], v[88:91], v[144:159]
    ds_read_b64_tr_b16 a[88:89], v41 offset:57856
    ds_read_b64_tr_b16 a[90:91], v41 offset:58368
    ds_read_b64_tr_b16 a[92:93], v41 offset:59904
    ds_read_b64_tr_b16 a[94:95], v41 offset:60416
    v_exp_f32_e64 v116, v116
    v_mfma_f32_32x32x16_bf16 v[144:159], a[44:47], v[92:95], v[144:159]
    ds_read_b128 v[96:99], v3 offset:256
    ds_read_b128 v[100:103], v3 offset:288
    ds_read_b128 v[104:107], v3 offset:320
    ds_read_b128 v[108:111], v3 offset:352
    v_exp_f32 v117, v117
    v_exp_f32 v118, v118
    v_exp_f32 v119, v119
    v_exp_f32 v120, v120
    v_exp_f32 v121, v121
    v_exp_f32 v122, v122
    v_exp_f32 v123, v123
    v_exp_f32 v124, v124
    v_exp_f32 v125, v125
    v_exp_f32 v126, v126
    v_exp_f32_e64 v127, v127
    v_pk_add_f32 v[112:113], v[112:113], s[60:61]
    v_pk_add_f32 v[114:115], v[114:115], s[60:61]
    v_pk_add_f32 v[116:117], v[116:117], s[60:61]
    v_pk_add_f32 v[118:119], v[118:119], s[60:61]
    v_pk_add_f32 v[120:121], v[120:121], s[60:61]
    v_pk_add_f32 v[122:123], v[122:123], s[60:61]
    v_pk_add_f32 v[124:125], v[124:125], s[60:61]
    v_pk_add_f32 v[126:127], v[126:127], s[60:61]
    v_rcp_f32 v112, v112
    v_rcp_f32 v113, v113
    v_rcp_f32 v114, v114
    v_rcp_f32 v115, v115
    v_rcp_f32 v116, v116
    v_rcp_f32 v117, v117
    v_rcp_f32 v118, v118
    v_rcp_f32 v119, v119
    v_rcp_f32 v120, v120
    v_rcp_f32 v121, v121
    v_rcp_f32 v122, v122
    v_rcp_f32 v123, v123
    v_rcp_f32 v124, v124
    v_rcp_f32 v125, v125
    v_rcp_f32 v126, v126
    v_rcp_f32 v127, v127
    v_pk_mul_f32 v[128:129], v[128:129], v[112:113]
    v_pk_mul_f32 v[130:131], v[130:131], v[114:115]
    v_pk_mul_f32 v[132:133], v[132:133], v[116:117]
    v_pk_mul_f32 v[134:135], v[134:135], v[118:119]
    v_pk_mul_f32 v[136:137], v[136:137], v[120:121]
    v_pk_mul_f32 v[138:139], v[138:139], v[122:123]
    v_pk_mul_f32 v[140:141], v[140:141], v[124:125]
    v_pk_mul_f32 v[142:143], v[142:143], v[126:127]
    v_pk_fma_f32 v[112:113], v[144:145], v[144:145], s[58:59] neg_lo:[1,0,0] neg_hi:[1,0,0]
    v_pk_fma_f32 v[114:115], v[146:147], v[146:147], s[58:59] neg_lo:[1,0,0] neg_hi:[1,0,0]
    v_pk_fma_f32 v[116:117], v[148:149], v[148:149], s[58:59] neg_lo:[1,0,0] neg_hi:[1,0,0]
    v_pk_fma_f32 v[118:119], v[150:151], v[150:151], s[58:59] neg_lo:[1,0,0] neg_hi:[1,0,0]
    v_pk_fma_f32 v[120:121], v[152:153], v[152:153], s[58:59] neg_lo:[1,0,0] neg_hi:[1,0,0]
    v_pk_fma_f32 v[122:123], v[154:155], v[154:155], s[58:59] neg_lo:[1,0,0] neg_hi:[1,0,0]
    v_pk_fma_f32 v[124:125], v[156:157], v[156:157], s[58:59] neg_lo:[1,0,0] neg_hi:[1,0,0]
    v_pk_fma_f32 v[126:127], v[158:159], v[158:159], s[58:59] neg_lo:[1,0,0] neg_hi:[1,0,0]
    v_pk_mul_f32 v[112:113], v[112:113], v[144:145]
    v_pk_mul_f32 v[114:115], v[114:115], v[146:147]
    v_pk_mul_f32 v[116:117], v[116:117], v[148:149]
    v_pk_mul_f32 v[118:119], v[118:119], v[150:151]
    v_pk_mul_f32 v[120:121], v[120:121], v[152:153]
    v_pk_mul_f32 v[122:123], v[122:123], v[154:155]
    v_pk_mul_f32 v[124:125], v[124:125], v[156:157]
    v_pk_mul_f32 v[126:127], v[126:127], v[158:159]
    s_waitcnt lgkmcnt(0)
    v_mfma_f32_32x32x16_bf16 v[160:175], a[48:51], v[72:75], v[96:111]
    s_waitcnt vmcnt(0)
    s_barrier
    v_cvt_pk_bf16_f32 v64, v128, v129
    v_cvt_pk_bf16_f32 v65, v130, v131
    v_cvt_pk_bf16_f32 v66, v132, v133
    v_cvt_pk_bf16_f32 v67, v134, v135
    v_cvt_pk_bf16_f32 v68, v136, v137
    v_mfma_f32_32x32x16_bf16 v[160:175], a[52:55], v[76:79], v[160:175]
    ds_read_b64_tr_b16 a[136:137], v42 offset:0
    ds_read_b64_tr_b16 a[138:139], v42 offset:1536
    ds_read_b64_tr_b16 a[140:141], v42 offset:3072
    s_add_u32 m0, s76, 98816
    s_nop 0
    buffer_load_dwordx4 v25, s[32:35], 0 offen offset:0 lds
    v_cvt_pk_bf16_f32 v69, v138, v139
    v_cvt_pk_bf16_f32 v70, v140, v141
    v_cvt_pk_bf16_f32 v71, v142, v143
    v_mfma_f32_32x32x16_bf16 v[160:175], a[56:59], v[80:83], v[160:175]
    ds_read_b64_tr_b16 a[142:143], v42 offset:4608
    ds_read_b64_tr_b16 a[144:145], v44 offset:0
    ds_read_b64_tr_b16 a[146:147], v44 offset:1536
    buffer_load_dwordx4 v25, s[32:35], 0 offen offset:1024 lds
    v_exp_f32 v112, v112
    v_exp_f32 v113, v113
    v_exp_f32 v114, v114
    v_exp_f32 v115, v115
    v_mfma_f32_32x32x16_bf16 v[160:175], a[60:63], v[84:87], v[160:175]
    ds_read_b64_tr_b16 a[148:149], v44 offset:3072
    ds_read_b64_tr_b16 a[150:151], v44 offset:4608
    ds_read_b64_tr_b16 a[152:153], v46 offset:0
    v_exp_f32 v116, v116
    v_exp_f32 v117, v117
    v_exp_f32 v118, v118
    v_exp_f32 v119, v119
    v_mfma_f32_32x32x16_bf16 v[160:175], a[64:67], v[88:91], v[160:175]
    ds_read_b64_tr_b16 a[154:155], v46 offset:1536
    ds_read_b64_tr_b16 a[156:157], v46 offset:3072
    ds_read_b64_tr_b16 a[158:159], v46 offset:4608
    buffer_load_dwordx4 v25, s[32:35], 0 offen offset:2048 lds
    v_exp_f32 v120, v120
    v_exp_f32 v121, v121
    v_exp_f32 v122, v122
    v_exp_f32 v123, v123
    v_mfma_f32_32x32x16_bf16 v[160:175], a[68:71], v[92:95], v[160:175]
    buffer_load_dwordx4 v25, s[32:35], 0 offen offset:3072 lds
    v_exp_f32 v124, v124
    v_exp_f32 v125, v125
    v_exp_f32 v126, v126
    v_exp_f32 v127, v127
    v_pk_add_f32 v[112:113], v[112:113], s[60:61]
    v_pk_add_f32 v[114:115], v[114:115], s[60:61]
    v_pk_add_f32 v[116:117], v[116:117], s[60:61]
    v_pk_add_f32 v[118:119], v[118:119], s[60:61]
    v_pk_add_f32 v[120:121], v[120:121], s[60:61]
    v_pk_add_f32 v[122:123], v[122:123], s[60:61]
    v_pk_add_f32 v[124:125], v[124:125], s[60:61]
    v_pk_add_f32 v[126:127], v[126:127], s[60:61]
    s_waitcnt lgkmcnt(0)
    v_mfma_f32_32x32x16_bf16 v[176:191], a[136:139], v[64:67], v[176:191]
    ds_read_b64_tr_b16 a[160:161], v43 offset:0
    ds_read_b64_tr_b16 a[162:163], v43 offset:1536
    s_add_u32 m0, s76, 102912
    s_nop 0
    buffer_load_dwordx4 v25, s[32:35], s99 offen offset:0 lds
    v_rcp_f32 v112, v112
    v_rcp_f32 v113, v113
    v_mfma_f32_32x32x16_bf16 v[176:191], a[140:143], v[68:71], v[176:191]
    ds_read_b64_tr_b16 a[164:165], v43 offset:3072
    ds_read_b64_tr_b16 a[166:167], v43 offset:4608
    v_rcp_f32 v114, v114
    v_rcp_f32 v115, v115
    v_mfma_f32_32x32x16_bf16 v[192:207], a[144:147], v[64:67], v[192:207]
    ds_read_b64_tr_b16 a[168:169], v45 offset:0
    ds_read_b64_tr_b16 a[170:171], v45 offset:1536
    buffer_load_dwordx4 v25, s[32:35], s99 offen offset:1024 lds
    v_add_u32 v25, 12288, v25
    ds_read_b128 v[96:99], v4 offset:256
    v_rcp_f32 v116, v116
    v_rcp_f32 v117, v117
    v_mfma_f32_32x32x16_bf16 v[192:207], a[148:151], v[68:71], v[192:207]
    ds_read_b64_tr_b16 a[172:173], v45 offset:3072
    ds_read_b64_tr_b16 a[174:175], v45 offset:4608
    s_add_u32 m0, s76, 123392
    s_nop 0
    buffer_load_dwordx4 v25, s[32:35], 0 offen offset:0 lds
    ds_read_b128 v[100:103], v4 offset:288
    v_rcp_f32 v118, v118
    v_rcp_f32_e64 v119, v119
    v_mfma_f32_32x32x16_bf16 v[208:223], a[152:155], v[64:67], v[208:223]
    ds_read_b64_tr_b16 a[176:177], v47 offset:0
    ds_read_b64_tr_b16 a[178:179], v47 offset:1536
    ds_read_b128 v[104:107], v4 offset:320
    v_rcp_f32 v120, v120
    v_rcp_f32 v121, v121
    v_mfma_f32_32x32x16_bf16 v[208:223], a[156:159], v[68:71], v[208:223]
    ds_read_b64_tr_b16 a[180:181], v47 offset:3072
    ds_read_b64_tr_b16 a[182:183], v47 offset:4608
    buffer_load_dwordx4 v25, s[32:35], 0 offen offset:1024 lds
    ds_read_b128 v[108:111], v4 offset:352
    v_rcp_f32 v122, v122
    v_rcp_f32 v123, v123
    v_rcp_f32 v124, v124
    v_rcp_f32 v125, v125
    v_rcp_f32 v126, v126
    v_rcp_f32 v127, v127
    v_pk_mul_f32 v[144:145], v[144:145], v[112:113]
    v_pk_mul_f32 v[146:147], v[146:147], v[114:115]
    v_pk_mul_f32 v[148:149], v[148:149], v[116:117]
    v_pk_mul_f32 v[150:151], v[150:151], v[118:119]
    v_pk_mul_f32 v[152:153], v[152:153], v[120:121]
    v_pk_mul_f32 v[154:155], v[154:155], v[122:123]
    v_pk_mul_f32 v[156:157], v[156:157], v[124:125]
    v_pk_mul_f32 v[158:159], v[158:159], v[126:127]
    v_pk_fma_f32 v[112:113], v[160:161], v[160:161], s[58:59] neg_lo:[1,0,0] neg_hi:[1,0,0]
    v_pk_fma_f32 v[114:115], v[162:163], v[162:163], s[58:59] neg_lo:[1,0,0] neg_hi:[1,0,0]
    v_pk_fma_f32 v[116:117], v[164:165], v[164:165], s[58:59] neg_lo:[1,0,0] neg_hi:[1,0,0]
    v_pk_fma_f32 v[118:119], v[166:167], v[166:167], s[58:59] neg_lo:[1,0,0] neg_hi:[1,0,0]
    v_pk_fma_f32 v[120:121], v[168:169], v[168:169], s[58:59] neg_lo:[1,0,0] neg_hi:[1,0,0]
    v_pk_fma_f32 v[122:123], v[170:171], v[170:171], s[58:59] neg_lo:[1,0,0] neg_hi:[1,0,0]
    v_pk_fma_f32 v[124:125], v[172:173], v[172:173], s[58:59] neg_lo:[1,0,0] neg_hi:[1,0,0]
    v_pk_fma_f32 v[126:127], v[174:175], v[174:175], s[58:59] neg_lo:[1,0,0] neg_hi:[1,0,0]
    v_pk_mul_f32 v[112:113], v[112:113], v[160:161]
    v_pk_mul_f32 v[114:115], v[114:115], v[162:163]
    v_pk_mul_f32 v[116:117], v[116:117], v[164:165]
    v_pk_mul_f32 v[118:119], v[118:119], v[166:167]
    v_pk_mul_f32 v[120:121], v[120:121], v[168:169]
    v_pk_mul_f32 v[122:123], v[122:123], v[170:171]
    v_pk_mul_f32 v[124:125], v[124:125], v[172:173]
    v_pk_mul_f32 v[126:127], v[126:127], v[174:175]
    s_waitcnt lgkmcnt(0)
    v_mfma_f32_32x32x16_bf16 v[128:143], a[72:75], v[72:75], v[96:111]
    ds_read_b64_tr_b16 a[96:97], v40 offset:0
    ds_read_b64_tr_b16 a[98:99], v40 offset:512
    buffer_load_dwordx4 v25, s[32:35], 0 offen offset:2048 lds
    v_cvt_pk_bf16_f32 v64, v144, v145
    v_cvt_pk_bf16_f32 v65, v146, v147
    v_cvt_pk_bf16_f32 v66, v148, v149
    v_cvt_pk_bf16_f32 v67, v150, v151
    v_mfma_f32_32x32x16_bf16 v[128:143], a[76:79], v[76:79], v[128:143]
    ds_read_b64_tr_b16 a[100:101], v40 offset:2048
    ds_read_b64_tr_b16 a[102:103], v40 offset:2560
    v_cvt_pk_bf16_f32 v68, v152, v153
    v_cvt_pk_bf16_f32 v69, v154, v155
    v_cvt_pk_bf16_f32 v70, v156, v157
    v_cvt_pk_bf16_f32 v71, v158, v159
    v_mfma_f32_32x32x16_bf16 v[128:143], a[80:83], v[80:83], v[128:143]
    ds_read_b64_tr_b16 a[104:105], v40 offset:4096
    ds_read_b64_tr_b16 a[106:107], v40 offset:4608
    buffer_load_dwordx4 v25, s[32:35], 0 offen offset:3072 lds
    v_exp_f32 v112, v112
    v_exp_f32 v113, v113
    v_exp_f32 v114, v114
    v_exp_f32_e64 v115, v115
    v_mfma_f32_32x32x16_bf16 v[128:143], a[84:87], v[84:87], v[128:143]
    ds_read_b64_tr_b16 a[108:109], v40 offset:6144
    ds_read_b64_tr_b16 a[110:111], v40 offset:6656
    s_add_u32 m0, s76, 127488
    s_nop 0
    buffer_load_dwordx4 v25, s[32:35], s99 offen offset:0 lds
    v_exp_f32 v116, v116
    v_exp_f32 v117, v117
    v_exp_f32 v118, v118
    v_exp_f32_e64 v119, v119
    v_mfma_f32_32x32x16_bf16 v[128:143], a[88:91], v[88:91], v[128:143]
    ds_read_b64_tr_b16 a[112:113], v40 offset:8192
    ds_read_b64_tr_b16 a[114:115], v40 offset:8704
    v_exp_f32 v120, v120
    v_exp_f32 v121, v121
    v_exp_f32 v122, v122
    v_exp_f32 v123, v123
    v_mfma_f32_32x32x16_bf16 v[128:143], a[92:95], v[92:95], v[128:143]
    ds_read_b64_tr_b16 a[116:117], v40 offset:10240
    ds_read_b64_tr_b16 a[118:119], v40 offset:10752
    buffer_load_dwordx4 v25, s[32:35], s99 offen offset:1024 lds
    v_exp_f32 v124, v124
    v_exp_f32 v125, v125
    v_exp_f32 v126, v126
    v_exp_f32 v127, v127
    v_pk_add_f32 v[112:113], v[112:113], s[60:61]
    v_pk_add_f32 v[114:115], v[114:115], s[60:61]
    v_pk_add_f32 v[116:117], v[116:117], s[60:61]
    v_pk_add_f32 v[118:119], v[118:119], s[60:61]
    v_pk_add_f32 v[120:121], v[120:121], s[60:61]
    v_pk_add_f32 v[122:123], v[122:123], s[60:61]
    v_pk_add_f32 v[124:125], v[124:125], s[60:61]
    v_pk_add_f32 v[126:127], v[126:127], s[60:61]
    v_mfma_f32_32x32x16_bf16 v[176:191], a[160:163], v[64:67], v[176:191]
    ds_read_b64_tr_b16 a[120:121], v41 offset:0
    ds_read_b64_tr_b16 a[122:123], v41 offset:512
    v_rcp_f32 v112, v112
    v_rcp_f32 v113, v113
    v_mfma_f32_32x32x16_bf16 v[176:191], a[164:167], v[68:71], v[176:191]
    ds_read_b64_tr_b16 a[124:125], v41 offset:2048
    ds_read_b64_tr_b16 a[126:127], v41 offset:2560
    v_rcp_f32 v114, v114
    v_rcp_f32 v115, v115
    v_mfma_f32_32x32x16_bf16 v[192:207], a[168:171], v[64:67], v[192:207]
    ds_read_b64_tr_b16 a[128:129], v41 offset:4096
    ds_read_b64_tr_b16 a[130:131], v41 offset:4608
    ds_read_b128 v[96:99], v3 offset:512
    v_rcp_f32 v116, v116
    v_rcp_f32 v117, v117
    v_mfma_f32_32x32x16_bf16 v[192:207], a[172:175], v[68:71], v[192:207]
    ds_read_b64_tr_b16 a[132:133], v41 offset:6144
    ds_read_b64_tr_b16 a[134:135], v41 offset:6656
    ds_read_b128 v[100:103], v3 offset:544
    v_rcp_f32 v118, v118
    v_rcp_f32 v119, v119
    v_mfma_f32_32x32x16_bf16 v[208:223], a[176:179], v[64:67], v[208:223]
    ds_read_b64_tr_b16 v[248:249], v41 offset:8192
    ds_read_b64_tr_b16 v[250:251], v41 offset:8704
    ds_read_b128 v[104:107], v3 offset:576
    v_rcp_f32 v120, v120
    v_rcp_f32 v121, v121
    v_mfma_f32_32x32x16_bf16 v[208:223], a[180:183], v[68:71], v[208:223]
    ds_read_b64_tr_b16 v[252:253], v41 offset:10240
    ds_read_b64_tr_b16 v[254:255], v41 offset:10752
    ds_read_b128 v[108:111], v3 offset:608
    v_rcp_f32 v122, v122
    v_rcp_f32 v123, v123
    v_rcp_f32 v124, v124
    v_rcp_f32 v125, v125
    v_rcp_f32 v126, v126
    v_rcp_f32 v127, v127
    v_pk_mul_f32 v[160:161], v[160:161], v[112:113]
    v_pk_mul_f32 v[162:163], v[162:163], v[114:115]
    v_pk_mul_f32 v[164:165], v[164:165], v[116:117]
    v_pk_mul_f32 v[166:167], v[166:167], v[118:119]
    v_pk_mul_f32 v[168:169], v[168:169], v[120:121]
    v_pk_mul_f32 v[170:171], v[170:171], v[122:123]
    v_pk_mul_f32 v[172:173], v[172:173], v[124:125]
    v_pk_mul_f32 v[174:175], v[174:175], v[126:127]
    v_pk_fma_f32 v[112:113], v[128:129], v[128:129], s[58:59] neg_lo:[1,0,0] neg_hi:[1,0,0]
    v_pk_fma_f32 v[114:115], v[130:131], v[130:131], s[58:59] neg_lo:[1,0,0] neg_hi:[1,0,0]
    v_pk_fma_f32 v[116:117], v[132:133], v[132:133], s[58:59] neg_lo:[1,0,0] neg_hi:[1,0,0]
    v_pk_fma_f32 v[118:119], v[134:135], v[134:135], s[58:59] neg_lo:[1,0,0] neg_hi:[1,0,0]
    v_pk_fma_f32 v[120:121], v[136:137], v[136:137], s[58:59] neg_lo:[1,0,0] neg_hi:[1,0,0]
    v_pk_fma_f32 v[122:123], v[138:139], v[138:139], s[58:59] neg_lo:[1,0,0] neg_hi:[1,0,0]
    v_pk_fma_f32 v[124:125], v[140:141], v[140:141], s[58:59] neg_lo:[1,0,0] neg_hi:[1,0,0]
    v_pk_fma_f32 v[126:127], v[142:143], v[142:143], s[58:59] neg_lo:[1,0,0] neg_hi:[1,0,0]
    v_pk_mul_f32 v[112:113], v[112:113], v[128:129]
    v_pk_mul_f32 v[114:115], v[114:115], v[130:131]
    v_pk_mul_f32 v[116:117], v[116:117], v[132:133]
    v_pk_mul_f32 v[118:119], v[118:119], v[134:135]
    v_pk_mul_f32 v[120:121], v[120:121], v[136:137]
    v_pk_mul_f32 v[122:123], v[122:123], v[138:139]
    v_pk_mul_f32 v[124:125], v[124:125], v[140:141]
    v_pk_mul_f32 v[126:127], v[126:127], v[142:143]
    s_waitcnt lgkmcnt(0)
    v_mfma_f32_32x32x16_bf16 v[144:159], a[96:99], v[72:75], v[96:111]
    s_waitcnt vmcnt(0)
    s_barrier
    v_cvt_pk_bf16_f32 v64, v160, v161
    v_cvt_pk_bf16_f32 v65, v162, v163
    v_cvt_pk_bf16_f32 v66, v164, v165
    v_cvt_pk_bf16_f32 v67, v166, v167
    v_cvt_pk_bf16_f32 v68, v168, v169
    v_mfma_f32_32x32x16_bf16 v[144:159], a[100:103], v[76:79], v[144:159]
    ds_read_b64_tr_b16 a[184:185], v42 offset:49664
    ds_read_b64_tr_b16 a[186:187], v42 offset:51200
    ds_read_b64_tr_b16 a[188:189], v42 offset:52736
    v_cvt_pk_bf16_f32 v69, v170, v171
    v_cvt_pk_bf16_f32 v70, v172, v173
    v_cvt_pk_bf16_f32 v71, v174, v175
    v_mfma_f32_32x32x16_bf16 v[144:159], a[104:107], v[80:83], v[144:159]
    ds_read_b64_tr_b16 a[190:191], v42 offset:54272
    ds_read_b64_tr_b16 a[192:193], v44 offset:49664
    ds_read_b64_tr_b16 a[194:195], v44 offset:51200
    v_exp_f32 v112, v112
    v_exp_f32_e64 v113, v113
    v_mfma_f32_32x32x16_bf16 v[144:159], a[108:111], v[84:87], v[144:159]
    ds_read_b64_tr_b16 a[196:197], v44 offset:52736
    ds_read_b64_tr_b16 a[198:199], v44 offset:54272
    ds_read_b64_tr_b16 a[200:201], v46 offset:49664
    v_exp_f32 v114, v114
    v_exp_f32 v115, v115
    v_mfma_f32_32x32x16_bf16 v[144:159], a[112:115], v[88:91], v[144:159]
    ds_read_b64_tr_b16 a[202:203], v46 offset:51200
    ds_read_b64_tr_b16 a[204:205], v46 offset:52736
    ds_read_b64_tr_b16 a[206:207], v46 offset:54272
    v_exp_f32 v116, v116
    v_exp_f32 v117, v117
    v_exp_f32 v118, v118
    v_mfma_f32_32x32x16_bf16 v[144:159], a[116:119], v[92:95], v[144:159]
    v_exp_f32 v119, v119
    v_exp_f32 v120, v120
    v_exp_f32 v121, v121
    v_exp_f32 v122, v122
    v_exp_f32 v123, v123
    v_exp_f32 v124, v124
    v_exp_f32 v125, v125
    v_exp_f32 v126, v126
    v_exp_f32 v127, v127
    v_pk_add_f32 v[112:113], v[112:113], s[60:61]
    v_pk_add_f32 v[114:115], v[114:115], s[60:61]
    v_pk_add_f32 v[116:117], v[116:117], s[60:61]
    v_pk_add_f32 v[118:119], v[118:119], s[60:61]
    v_pk_add_f32 v[120:121], v[120:121], s[60:61]
    v_pk_add_f32 v[122:123], v[122:123], s[60:61]
    v_pk_add_f32 v[124:125], v[124:125], s[60:61]
    v_pk_add_f32 v[126:127], v[126:127], s[60:61]
    s_waitcnt lgkmcnt(0)
    v_mfma_f32_32x32x16_bf16 v[176:191], a[184:187], v[64:67], v[176:191]
    ds_read_b64_tr_b16 a[208:209], v43 offset:49664
    ds_read_b64_tr_b16 a[210:211], v43 offset:51200
    v_rcp_f32 v112, v112
    v_rcp_f32_e64 v113, v113
    v_mfma_f32_32x32x16_bf16 v[176:191], a[188:191], v[68:71], v[176:191]
    ds_read_b64_tr_b16 a[212:213], v43 offset:52736
    ds_read_b64_tr_b16 a[214:215], v43 offset:54272
    v_rcp_f32 v114, v114
    v_rcp_f32 v115, v115
    v_mfma_f32_32x32x16_bf16 v[192:207], a[192:195], v[64:67], v[192:207]
    ds_read_b64_tr_b16 a[216:217], v45 offset:49664
    ds_read_b64_tr_b16 a[218:219], v45 offset:51200
    ds_read_b128 v[96:99], v4 offset:512
    v_rcp_f32 v116, v116
    v_rcp_f32 v117, v117
    v_mfma_f32_32x32x16_bf16 v[192:207], a[196:199], v[68:71], v[192:207]
    ds_read_b64_tr_b16 a[220:221], v45 offset:52736
    ds_read_b64_tr_b16 a[222:223], v45 offset:54272
    ds_read_b128 v[100:103], v4 offset:544
    v_rcp_f32 v118, v118
    v_rcp_f32 v119, v119
    v_mfma_f32_32x32x16_bf16 v[208:223], a[200:203], v[64:67], v[208:223]
    ds_read_b64_tr_b16 a[224:225], v47 offset:49664
    ds_read_b64_tr_b16 a[226:227], v47 offset:51200
    ds_read_b128 v[104:107], v4 offset:576
    v_rcp_f32 v120, v120
    v_rcp_f32 v121, v121
    v_mfma_f32_32x32x16_bf16 v[208:223], a[204:207], v[68:71], v[208:223]
    ds_read_b64_tr_b16 a[228:229], v47 offset:52736
    ds_read_b64_tr_b16 a[230:231], v47 offset:54272
    ds_read_b128 v[108:111], v4 offset:608
    v_rcp_f32 v122, v122
    v_rcp_f32 v123, v123
    v_rcp_f32 v124, v124
    v_rcp_f32 v125, v125
    v_rcp_f32 v126, v126
    v_rcp_f32 v127, v127
    v_pk_mul_f32 v[128:129], v[128:129], v[112:113]
    v_pk_mul_f32 v[130:131], v[130:131], v[114:115]
    v_pk_mul_f32 v[132:133], v[132:133], v[116:117]
    v_pk_mul_f32 v[134:135], v[134:135], v[118:119]
    v_pk_mul_f32 v[136:137], v[136:137], v[120:121]
    v_pk_mul_f32 v[138:139], v[138:139], v[122:123]
    v_pk_mul_f32 v[140:141], v[140:141], v[124:125]
    v_pk_mul_f32 v[142:143], v[142:143], v[126:127]
    v_pk_fma_f32 v[112:113], v[144:145], v[144:145], s[58:59] neg_lo:[1,0,0] neg_hi:[1,0,0]
    v_pk_fma_f32 v[114:115], v[146:147], v[146:147], s[58:59] neg_lo:[1,0,0] neg_hi:[1,0,0]
    v_pk_fma_f32 v[116:117], v[148:149], v[148:149], s[58:59] neg_lo:[1,0,0] neg_hi:[1,0,0]
    v_pk_fma_f32 v[118:119], v[150:151], v[150:151], s[58:59] neg_lo:[1,0,0] neg_hi:[1,0,0]
    v_pk_fma_f32 v[120:121], v[152:153], v[152:153], s[58:59] neg_lo:[1,0,0] neg_hi:[1,0,0]
    v_pk_fma_f32 v[122:123], v[154:155], v[154:155], s[58:59] neg_lo:[1,0,0] neg_hi:[1,0,0]
    v_pk_fma_f32 v[124:125], v[156:157], v[156:157], s[58:59] neg_lo:[1,0,0] neg_hi:[1,0,0]
    v_pk_fma_f32 v[126:127], v[158:159], v[158:159], s[58:59] neg_lo:[1,0,0] neg_hi:[1,0,0]
    v_pk_mul_f32 v[112:113], v[112:113], v[144:145]
    v_pk_mul_f32 v[114:115], v[114:115], v[146:147]
    v_pk_mul_f32 v[116:117], v[116:117], v[148:149]
    v_pk_mul_f32 v[118:119], v[118:119], v[150:151]
    v_pk_mul_f32 v[120:121], v[120:121], v[152:153]
    v_pk_mul_f32 v[122:123], v[122:123], v[154:155]
    v_pk_mul_f32 v[124:125], v[124:125], v[156:157]
    v_pk_mul_f32 v[126:127], v[126:127], v[158:159]
    s_waitcnt lgkmcnt(0)
    v_mfma_f32_32x32x16_bf16 v[160:175], a[120:123], v[72:75], v[96:111]
    v_add_u32 v13, s74, v13
    v_add_u32 v42, 24576, v42
    v_add_u32 v43, 24576, v43
    v_add_u32 v44, 24576, v44
    v_add_u32 v45, 24576, v45
    v_add_u32 v46, 24576, v46
    v_mfma_f32_32x32x16_bf16 v[160:175], a[124:127], v[76:79], v[160:175]
    ds_read_b128 v[72:75], v13 offset:0
    v_add_u32 v47, 24576, v47
    v_cvt_pk_bf16_f32 v64, v128, v129
    v_cvt_pk_bf16_f32 v65, v130, v131
    v_cvt_pk_bf16_f32 v66, v132, v133
    v_cvt_pk_bf16_f32 v67, v134, v135
    v_mfma_f32_32x32x16_bf16 v[160:175], a[128:131], v[80:83], v[160:175]
    ds_read_b128 v[76:79], v13 offset:6304
    v_cvt_pk_bf16_f32 v68, v136, v137
    v_cvt_pk_bf16_f32 v69, v138, v139
    v_cvt_pk_bf16_f32 v70, v140, v141
    v_cvt_pk_bf16_f32 v71, v142, v143
    v_exp_f32 v112, v112
    v_mfma_f32_32x32x16_bf16 v[160:175], a[132:135], v[84:87], v[160:175]
    ds_read_b128 v[80:83], v13 offset:12608
    v_exp_f32 v113, v113
    v_exp_f32 v114, v114
    v_exp_f32 v115, v115
    v_exp_f32 v116, v116
    v_exp_f32 v117, v117
    v_mfma_f32_32x32x16_bf16 v[160:175], v[248:251], v[88:91], v[160:175]
    ds_read_b128 v[84:87], v13 offset:18912
    v_exp_f32 v118, v118
    v_exp_f32 v119, v119
    v_exp_f32 v120, v120
    v_exp_f32 v121, v121
    v_exp_f32 v122, v122
    v_mfma_f32_32x32x16_bf16 v[160:175], v[252:255], v[92:95], v[160:175]
    ds_read_b128 v[88:91], v13 offset:25216
    v_exp_f32 v123, v123
    v_exp_f32 v124, v124
    v_exp_f32 v125, v125
    v_exp_f32 v126, v126
    v_exp_f32 v127, v127
    v_pk_add_f32 v[112:113], v[112:113], s[60:61]
    v_pk_add_f32 v[114:115], v[114:115], s[60:61]
    v_pk_add_f32 v[116:117], v[116:117], s[60:61]
    v_pk_add_f32 v[118:119], v[118:119], s[60:61]
    v_pk_add_f32 v[120:121], v[120:121], s[60:61]
    v_pk_add_f32 v[122:123], v[122:123], s[60:61]
    v_pk_add_f32 v[124:125], v[124:125], s[60:61]
    v_pk_add_f32 v[126:127], v[126:127], s[60:61]
    v_mfma_f32_32x32x16_bf16 v[176:191], a[208:211], v[64:67], v[176:191]
    ds_read_b64_tr_b16 a[232:233], v42 offset:49664
    ds_read_b64_tr_b16 a[234:235], v42 offset:51200
    ds_read_b128 v[92:95], v13 offset:31520
    v_rcp_f32 v112, v112
    v_rcp_f32 v113, v113
    v_mfma_f32_32x32x16_bf16 v[176:191], a[212:215], v[68:71], v[176:191]
    ds_read_b64_tr_b16 a[236:237], v42 offset:52736
    ds_read_b64_tr_b16 a[238:239], v42 offset:54272
    v_rcp_f32 v114, v114
    v_rcp_f32 v115, v115
    v_mfma_f32_32x32x16_bf16 v[192:207], a[216:219], v[64:67], v[192:207]
    ds_read_b64_tr_b16 a[240:241], v44 offset:49664
    ds_read_b64_tr_b16 a[242:243], v44 offset:51200
    ds_read_b128 v[96:99], v3 offset:0
    v_rcp_f32 v116, v116
    v_rcp_f32 v117, v117
    v_mfma_f32_32x32x16_bf16 v[192:207], a[220:223], v[68:71], v[192:207]
    ds_read_b64_tr_b16 a[244:245], v44 offset:52736
    ds_read_b64_tr_b16 a[246:247], v44 offset:54272
    ds_read_b128 v[100:103], v3 offset:32
    v_rcp_f32 v118, v118
    v_rcp_f32 v119, v119
    v_mfma_f32_32x32x16_bf16 v[208:223], a[224:227], v[64:67], v[208:223]
    ds_read_b64_tr_b16 a[248:249], v46 offset:49664
    ds_read_b64_tr_b16 a[250:251], v46 offset:51200
    ds_read_b128 v[104:107], v3 offset:64
    v_rcp_f32 v120, v120
    v_rcp_f32 v121, v121
    v_mfma_f32_32x32x16_bf16 v[208:223], a[228:231], v[68:71], v[208:223]
    ds_read_b64_tr_b16 a[252:253], v46 offset:52736
    ds_read_b64_tr_b16 a[254:255], v46 offset:54272
    ds_read_b128 v[108:111], v3 offset:96
    v_rcp_f32 v122, v122
    v_rcp_f32 v123, v123
    v_rcp_f32 v124, v124
    v_rcp_f32 v125, v125
    v_rcp_f32 v126, v126
    v_rcp_f32 v127, v127
    v_pk_mul_f32 v[144:145], v[144:145], v[112:113]
    v_pk_mul_f32 v[146:147], v[146:147], v[114:115]
    v_pk_mul_f32 v[148:149], v[148:149], v[116:117]
    v_pk_mul_f32 v[150:151], v[150:151], v[118:119]
    v_pk_mul_f32 v[152:153], v[152:153], v[120:121]
    v_pk_mul_f32 v[154:155], v[154:155], v[122:123]
    v_pk_mul_f32 v[156:157], v[156:157], v[124:125]
    v_pk_mul_f32 v[158:159], v[158:159], v[126:127]
    v_pk_fma_f32 v[112:113], v[160:161], v[160:161], s[58:59] neg_lo:[1,0,0] neg_hi:[1,0,0]
    v_pk_fma_f32 v[114:115], v[162:163], v[162:163], s[58:59] neg_lo:[1,0,0] neg_hi:[1,0,0]
    v_pk_fma_f32 v[116:117], v[164:165], v[164:165], s[58:59] neg_lo:[1,0,0] neg_hi:[1,0,0]
    v_pk_fma_f32 v[118:119], v[166:167], v[166:167], s[58:59] neg_lo:[1,0,0] neg_hi:[1,0,0]
    v_pk_fma_f32 v[120:121], v[168:169], v[168:169], s[58:59] neg_lo:[1,0,0] neg_hi:[1,0,0]
    v_pk_fma_f32 v[122:123], v[170:171], v[170:171], s[58:59] neg_lo:[1,0,0] neg_hi:[1,0,0]
    v_pk_fma_f32 v[124:125], v[172:173], v[172:173], s[58:59] neg_lo:[1,0,0] neg_hi:[1,0,0]
    v_pk_fma_f32 v[126:127], v[174:175], v[174:175], s[58:59] neg_lo:[1,0,0] neg_hi:[1,0,0]
    v_pk_mul_f32 v[112:113], v[112:113], v[160:161]
    v_pk_mul_f32 v[114:115], v[114:115], v[162:163]
    v_pk_mul_f32 v[116:117], v[116:117], v[164:165]
    v_pk_mul_f32 v[118:119], v[118:119], v[166:167]
    v_pk_mul_f32 v[120:121], v[120:121], v[168:169]
    v_pk_mul_f32 v[122:123], v[122:123], v[170:171]
    v_pk_mul_f32 v[124:125], v[124:125], v[172:173]
    v_pk_mul_f32 v[126:127], v[126:127], v[174:175]
    s_waitcnt lgkmcnt(0)
    v_mfma_f32_32x32x16_bf16 v[128:143], a[0:3], v[72:75], v[96:111]
    ds_read_b64_tr_b16 v[224:225], v43 offset:49664
    ds_read_b64_tr_b16 v[226:227], v43 offset:51200
    v_cvt_pk_bf16_f32 v64, v144, v145
    v_cvt_pk_bf16_f32 v65, v146, v147
    v_cvt_pk_bf16_f32 v66, v148, v149
    v_cvt_pk_bf16_f32 v67, v150, v151
    v_mfma_f32_32x32x16_bf16 v[128:143], a[4:7], v[76:79], v[128:143]
L_pad3:
    s_cbranch_execz L_go
    ds_read_b64_tr_b16 v[228:229], v43 offset:52736
    ds_read_b64_tr_b16 v[230:231], v43 offset:54272
    v_cvt_pk_bf16_f32 v68, v152, v153
    v_cvt_pk_bf16_f32 v69, v154, v155
    v_cvt_pk_bf16_f32 v70, v156, v157
    v_cvt_pk_bf16_f32 v71, v158, v159
    v_mfma_f32_32x32x16_bf16 v[128:143], a[8:11], v[80:83], v[128:143]
    ds_read_b64_tr_b16 v[232:233], v45 offset:49664
    ds_read_b64_tr_b16 v[234:235], v45 offset:51200
    v_exp_f32 v112, v112
    v_exp_f32 v113, v113
    v_exp_f32 v114, v114
    v_exp_f32 v115, v115
    v_mfma_f32_32x32x16_bf16 v[128:143], a[12:15], v[84:87], v[128:143]
    ds_read_b64_tr_b16 v[236:237], v45 offset:52736
    ds_read_b64_tr_b16 v[238:239], v45 offset:54272
    v_exp_f32 v116, v116
    v_exp_f32 v117, v117
    v_exp_f32 v118, v118
    v_exp_f32 v119, v119
    v_mfma_f32_32x32x16_bf16 v[128:143], a[16:19], v[88:91], v[128:143]
    ds_read_b64_tr_b16 v[240:241], v47 offset:49664
    ds_read_b64_tr_b16 v[242:243], v47 offset:51200
    v_exp_f32 v120, v120
    v_exp_f32 v121, v121
    v_exp_f32 v122, v122
    v_exp_f32 v123, v123
    v_mfma_f32_32x32x16_bf16 v[128:143], a[20:23], v[92:95], v[128:143]
    ds_read_b64_tr_b16 v[244:245], v47 offset:52736
    ds_read_b64_tr_b16 v[246:247], v47 offset:54272
    v_exp_f32 v124, v124
    v_exp_f32 v125, v125
    v_exp_f32 v126, v126
    v_exp_f32 v127, v127
    v_pk_add_f32 v[112:113], v[112:113], s[60:61]
    v_pk_add_f32 v[114:115], v[114:115], s[60:61]
    v_pk_add_f32 v[116:117], v[116:117], s[60:61]
    v_pk_add_f32 v[118:119], v[118:119], s[60:61]
    v_pk_add_f32 v[120:121], v[120:121], s[60:61]
    v_pk_add_f32 v[122:123], v[122:123], s[60:61]
    v_pk_add_f32 v[124:125], v[124:125], s[60:61]
    v_pk_add_f32 v[126:127], v[126:127], s[60:61]
    v_mfma_f32_32x32x16_bf16 v[176:191], a[232:235], v[64:67], v[176:191]
    ds_read_b128 v[96:99], v4 offset:0
    ds_read_b128 v[100:103], v4 offset:32
    v_add_u32 v14, s77, v1
    v_add_u32 v15, s78, v1
    v_rcp_f32_e64 v112, v112
    v_mfma_f32_32x32x16_bf16 v[176:191], a[236:239], v[68:71], v[176:191]
    ds_read_b128 v[104:107], v4 offset:64
    ds_read_b128 v[108:111], v4 offset:96
    v_rcp_f32 v113, v113
    v_rcp_f32 v114, v114
    v_mfma_f32_32x32x16_bf16 v[192:207], a[240:243], v[64:67], v[192:207]
    v_mul_f32 v160, v160, v112
    v_mul_f32 v161, v161, v113
    v_rcp_f32 v115, v115
    v_rcp_f32 v116, v116
    v_mfma_f32_32x32x16_bf16 v[192:207], a[244:247], v[68:71], v[192:207]
    v_rcp_f32 v117, v117
    v_rcp_f32 v118, v118
    v_rcp_f32 v119, v119
    v_mfma_f32_32x32x16_bf16 v[208:223], a[248:251], v[64:67], v[208:223]
    v_rcp_f32 v120, v120
    v_rcp_f32 v121, v121
    v_rcp_f32 v122, v122
    v_mfma_f32_32x32x16_bf16 v[208:223], a[252:255], v[68:71], v[208:223]
    s_waitcnt lgkmcnt(0)
    v_rcp_f32 v123, v123
    v_rcp_f32 v124, v124
    v_rcp_f32 v125, v125
    v_rcp_f32 v126, v126
    v_rcp_f32 v127, v127
    v_pk_mul_f32 v[162:163], v[162:163], v[114:115]
    v_pk_mul_f32 v[164:165], v[164:165], v[116:117]
    v_pk_mul_f32 v[166:167], v[166:167], v[118:119]
    v_pk_mul_f32 v[168:169], v[168:169], v[120:121]
    v_pk_mul_f32 v[170:171], v[170:171], v[122:123]
    v_pk_mul_f32 v[172:173], v[172:173], v[124:125]
    v_pk_mul_f32 v[174:175], v[174:175], v[126:127]
    v_pk_fma_f32 v[112:113], v[128:129], v[128:129], s[58:59] neg_lo:[1,0,0] neg_hi:[1,0,0]
    v_pk_fma_f32 v[114:115], v[130:131], v[130:131], s[58:59] neg_lo:[1,0,0] neg_hi:[1,0,0]
    v_pk_fma_f32 v[116:117], v[132:133], v[132:133], s[58:59] neg_lo:[1,0,0] neg_hi:[1,0,0]
    v_pk_fma_f32 v[118:119], v[134:135], v[134:135], s[58:59] neg_lo:[1,0,0] neg_hi:[1,0,0]
    v_pk_fma_f32 v[120:121], v[136:137], v[136:137], s[58:59] neg_lo:[1,0,0] neg_hi:[1,0,0]
    v_pk_fma_f32 v[122:123], v[138:139], v[138:139], s[58:59] neg_lo:[1,0,0] neg_hi:[1,0,0]
    v_pk_fma_f32 v[124:125], v[140:141], v[140:141], s[58:59] neg_lo:[1,0,0] neg_hi:[1,0,0]
    v_pk_fma_f32 v[126:127], v[142:143], v[142:143], s[58:59] neg_lo:[1,0,0] neg_hi:[1,0,0]
    v_pk_mul_f32 v[112:113], v[112:113], v[128:129]
    v_pk_mul_f32 v[114:115], v[114:115], v[130:131]
    v_pk_mul_f32 v[116:117], v[116:117], v[132:133]
    v_pk_mul_f32 v[118:119], v[118:119], v[134:135]
    v_pk_mul_f32 v[120:121], v[120:121], v[136:137]
    v_pk_mul_f32 v[122:123], v[122:123], v[138:139]
    v_pk_mul_f32 v[124:125], v[124:125], v[140:141]
    v_pk_mul_f32 v[126:127], v[126:127], v[142:143]
    v_mfma_f32_32x32x16_bf16 v[144:159], a[24:27], v[72:75], v[96:111]
    v_cvt_pk_bf16_f32 v64, v160, v161
    v_cvt_pk_bf16_f32 v65, v162, v163
    v_cvt_pk_bf16_f32 v66, v164, v165
    v_cvt_pk_bf16_f32 v67, v166, v167
    v_cvt_pk_bf16_f32 v68, v168, v169
    v_cvt_pk_bf16_f32 v69, v170, v171
    v_mfma_f32_32x32x16_bf16 v[144:159], a[28:31], v[76:79], v[144:159]
    v_cvt_pk_bf16_f32 v70, v172, v173
    v_cvt_pk_bf16_f32 v71, v174, v175
    v_exp_f32 v112, v112
    v_exp_f32 v113, v113
    v_mfma_f32_32x32x16_bf16 v[144:159], a[32:35], v[80:83], v[144:159]
    v_exp_f32 v114, v114
    v_exp_f32 v115, v115
    v_exp_f32 v116, v116
    v_mfma_f32_32x32x16_bf16 v[144:159], a[36:39], v[84:87], v[144:159]
    v_exp_f32 v117, v117
    v_exp_f32 v118, v118
    v_exp_f32 v119, v119
    v_mfma_f32_32x32x16_bf16 v[144:159], a[40:43], v[88:91], v[144:159]
    v_exp_f32 v120, v120
    v_exp_f32 v121, v121
    v_exp_f32 v122, v122
    v_mfma_f32_32x32x16_bf16 v[144:159], a[44:47], v[92:95], v[144:159]
    v_exp_f32 v123, v123
    v_exp_f32 v124, v124
    v_exp_f32 v125, v125
    v_exp_f32 v126, v126
    v_exp_f32 v127, v127
    v_pk_add_f32 v[112:113], v[112:113], s[60:61]
    v_pk_add_f32 v[114:115], v[114:115], s[60:61]
    v_pk_add_f32 v[116:117], v[116:117], s[60:61]
    v_pk_add_f32 v[118:119], v[118:119], s[60:61]
    v_pk_add_f32 v[120:121], v[120:121], s[60:61]
    v_pk_add_f32 v[122:123], v[122:123], s[60:61]
    v_pk_add_f32 v[124:125], v[124:125], s[60:61]
    v_pk_add_f32 v[126:127], v[126:127], s[60:61]
    v_mfma_f32_32x32x16_bf16 v[176:191], v[224:227], v[64:67], v[176:191]
    ds_read_b128 v[96:99], v3 offset:256
    v_rcp_f32 v112, v112
    v_rcp_f32 v113, v113
    v_rcp_f32 v114, v114
    v_mfma_f32_32x32x16_bf16 v[176:191], v[228:231], v[68:71], v[176:191]
    ds_read_b128 v[100:103], v3 offset:288
    v_mul_f32 v128, v128, v112
    v_mul_f32 v129, v129, v113
    v_rcp_f32 v115, v115
    v_mfma_f32_32x32x16_bf16 v[192:207], v[232:235], v[64:67], v[192:207]
    ds_read_b128 v[104:107], v3 offset:320
    v_rcp_f32 v116, v116
    v_rcp_f32 v117, v117
    v_rcp_f32 v118, v118
    v_mfma_f32_32x32x16_bf16 v[192:207], v[236:239], v[68:71], v[192:207]
    ds_read_b128 v[108:111], v3 offset:352
    v_rcp_f32 v119, v119
    v_rcp_f32 v120, v120
    v_rcp_f32 v121, v121
    v_mfma_f32_32x32x16_bf16 v[208:223], v[240:243], v[64:67], v[208:223]
    ds_write_b128 v14, v[176:179] offset:0
    v_rcp_f32 v122, v122
    v_rcp_f32 v123, v123
    v_rcp_f32 v124, v124
    v_rcp_f32 v125, v125
    v_mfma_f32_32x32x16_bf16 v[208:223], v[244:247], v[68:71], v[208:223]
    ds_write_b128 v14, v[180:183] offset:1024
    v_rcp_f32 v126, v126
    v_rcp_f32 v127, v127
    v_pk_mul_f32 v[130:131], v[130:131], v[114:115]
    v_pk_mul_f32 v[132:133], v[132:133], v[116:117]
    v_pk_mul_f32 v[134:135], v[134:135], v[118:119]
    v_pk_mul_f32 v[136:137], v[136:137], v[120:121]
    v_pk_mul_f32 v[138:139], v[138:139], v[122:123]
    v_pk_mul_f32 v[140:141], v[140:141], v[124:125]
    v_pk_mul_f32 v[142:143], v[142:143], v[126:127]
    v_pk_fma_f32 v[112:113], v[144:145], v[144:145], s[58:59] neg_lo:[1,0,0] neg_hi:[1,0,0]
    v_pk_fma_f32 v[114:115], v[146:147], v[146:147], s[58:59] neg_lo:[1,0,0] neg_hi:[1,0,0]
    v_pk_fma_f32 v[116:117], v[148:149], v[148:149], s[58:59] neg_lo:[1,0,0] neg_hi:[1,0,0]
    v_pk_fma_f32 v[118:119], v[150:151], v[150:151], s[58:59] neg_lo:[1,0,0] neg_hi:[1,0,0]
    v_pk_fma_f32 v[120:121], v[152:153], v[152:153], s[58:59] neg_lo:[1,0,0] neg_hi:[1,0,0]
    v_pk_fma_f32 v[122:123], v[154:155], v[154:155], s[58:59] neg_lo:[1,0,0] neg_hi:[1,0,0]
    v_pk_fma_f32 v[124:125], v[156:157], v[156:157], s[58:59] neg_lo:[1,0,0] neg_hi:[1,0,0]
    v_pk_fma_f32 v[126:127], v[158:159], v[158:159], s[58:59] neg_lo:[1,0,0] neg_hi:[1,0,0]
    v_pk_mul_f32 v[112:113], v[112:113], v[144:145]
    v_pk_mul_f32 v[114:115], v[114:115], v[146:147]
    v_pk_mul_f32 v[116:117], v[116:117], v[148:149]
    v_pk_mul_f32 v[118:119], v[118:119], v[150:151]
    v_pk_mul_f32 v[120:121], v[120:121], v[152:153]
    v_pk_mul_f32 v[122:123], v[122:123], v[154:155]
    v_pk_mul_f32 v[124:125], v[124:125], v[156:157]
    v_pk_mul_f32 v[126:127], v[126:127], v[158:159]
    s_waitcnt lgkmcnt(2)
    v_mfma_f32_32x32x16_bf16 v[160:175], a[48:51], v[72:75], v[96:111]
    ds_write_b128 v14, v[184:187] offset:2048
    v_cvt_pk_bf16_f32 v64, v128, v129
    v_cvt_pk_bf16_f32 v65, v130, v131
    v_cvt_pk_bf16_f32 v66, v132, v133
    v_cvt_pk_bf16_f32 v67, v134, v135
    v_cvt_pk_bf16_f32 v68, v136, v137
    v_cvt_pk_bf16_f32 v69, v138, v139
    v_cvt_pk_bf16_f32 v70, v140, v141
    v_cvt_pk_bf16_f32 v71, v142, v143
    v_mfma_f32_32x32x16_bf16 v[160:175], a[52:55], v[76:79], v[160:175]
    ds_write_b128 v14, v[188:191] offset:3072
    v_exp_f32 v112, v112
    v_exp_f32 v113, v113
    v_exp_f32 v114, v114
    v_exp_f32 v115, v115
    v_mfma_f32_32x32x16_bf16 v[160:175], a[56:59], v[80:83], v[160:175]
    ds_write_b128 v14, v[192:195] offset:4096
    v_exp_f32 v116, v116
    v_exp_f32_e64 v117, v117
    v_mfma_f32_32x32x16_bf16 v[160:175], a[60:63], v[84:87], v[160:175]
    ds_read_b128 v[96:99], v4 offset:256
    ds_read_b128 v[100:103], v4 offset:288
    ds_read_b128 v[104:107], v4 offset:320
    ds_read_b128 v[108:111], v4 offset:352
    v_exp_f32 v118, v118
    v_exp_f32 v119, v119
    v_mfma_f32_32x32x16_bf16 v[160:175], a[64:67], v[88:91], v[160:175]
    ds_write_b128 v14, v[196:199] offset:5120
    v_exp_f32 v120, v120
    v_exp_f32 v121, v121
    v_exp_f32 v122, v122
    v_exp_f32 v123, v123
    v_mfma_f32_32x32x16_bf16 v[160:175], a[68:71], v[92:95], v[160:175]
    ds_write_b128 v14, v[200:203] offset:6144
    v_exp_f32 v124, v124
    v_exp_f32 v125, v125
    v_exp_f32 v126, v126
    v_exp_f32 v127, v127
    v_pk_add_f32 v[112:113], v[112:113], s[60:61]
    v_pk_add_f32 v[114:115], v[114:115], s[60:61]
    v_pk_add_f32 v[116:117], v[116:117], s[60:61]
    v_pk_add_f32 v[118:119], v[118:119], s[60:61]
    v_pk_add_f32 v[120:121], v[120:121], s[60:61]
    v_pk_add_f32 v[122:123], v[122:123], s[60:61]
    v_pk_add_f32 v[124:125], v[124:125], s[60:61]
    v_pk_add_f32 v[126:127], v[126:127], s[60:61]
    s_waitcnt lgkmcnt(2)
    v_mfma_f32_32x32x16_bf16 v[128:143], a[72:75], v[72:75], v[96:111]
    ds_write_b128 v14, v[204:207] offset:7168
    v_rcp_f32 v112, v112
    v_rcp_f32 v113, v113
    v_rcp_f32 v114, v114
    v_rcp_f32 v115, v115
    v_mfma_f32_32x32x16_bf16 v[128:143], a[76:79], v[76:79], v[128:143]
    ds_write_b128 v14, v[208:211] offset:8192
    v_rcp_f32 v116, v116
    v_rcp_f32 v117, v117
    v_rcp_f32 v118, v118
    v_rcp_f32 v119, v119
    v_mfma_f32_32x32x16_bf16 v[128:143], a[80:83], v[80:83], v[128:143]
    ds_write_b128 v14, v[212:215] offset:9216
    v_rcp_f32 v120, v120
    v_rcp_f32 v121, v121
    v_rcp_f32 v122, v122
    v_rcp_f32 v123, v123
    v_mfma_f32_32x32x16_bf16 v[128:143], a[84:87], v[84:87], v[128:143]
    ds_write_b128 v14, v[216:219] offset:10240
    v_rcp_f32 v124, v124
    v_rcp_f32_e64 v125, v125
    v_mfma_f32_32x32x16_bf16 v[128:143], a[88:91], v[88:91], v[128:143]
    ds_read_b128 v[96:99], v3 offset:512
    ds_read_b128 v[100:103], v3 offset:544
    ds_read_b128 v[104:107], v3 offset:576
    ds_read_b128 v[108:111], v3 offset:608
    v_rcp_f32 v126, v126
    v_mfma_f32_32x32x16_bf16 v[128:143], a[92:95], v[92:95], v[128:143]
    ds_write_b128 v14, v[220:223] offset:11264
    v_rcp_f32 v127, v127
    v_pk_mul_f32 v[144:145], v[144:145], v[112:113]
    v_pk_mul_f32 v[146:147], v[146:147], v[114:115]
    v_pk_mul_f32 v[148:149], v[148:149], v[116:117]
    v_pk_mul_f32 v[150:151], v[150:151], v[118:119]
    v_pk_mul_f32 v[152:153], v[152:153], v[120:121]
    v_pk_mul_f32 v[154:155], v[154:155], v[122:123]
    v_pk_mul_f32 v[156:157], v[156:157], v[124:125]
    v_pk_mul_f32 v[158:159], v[158:159], v[126:127]
    v_pk_fma_f32 v[112:113], v[160:161], v[160:161], s[58:59] neg_lo:[1,0,0] neg_hi:[1,0,0]
    v_pk_fma_f32 v[114:115], v[162:163], v[162:163], s[58:59] neg_lo:[1,0,0] neg_hi:[1,0,0]
    v_pk_fma_f32 v[116:117], v[164:165], v[164:165], s[58:59] neg_lo:[1,0,0] neg_hi:[1,0,0]
    v_pk_fma_f32 v[118:119], v[166:167], v[166:167], s[58:59] neg_lo:[1,0,0] neg_hi:[1,0,0]
    v_pk_fma_f32 v[120:121], v[168:169], v[168:169], s[58:59] neg_lo:[1,0,0] neg_hi:[1,0,0]
    v_pk_fma_f32 v[122:123], v[170:171], v[170:171], s[58:59] neg_lo:[1,0,0] neg_hi:[1,0,0]
    v_pk_fma_f32 v[124:125], v[172:173], v[172:173], s[58:59] neg_lo:[1,0,0] neg_hi:[1,0,0]
    v_pk_fma_f32 v[126:127], v[174:175], v[174:175], s[58:59] neg_lo:[1,0,0] neg_hi:[1,0,0]
    v_pk_mul_f32 v[112:113], v[112:113], v[160:161]
    v_pk_mul_f32 v[114:115], v[114:115], v[162:163]
    v_pk_mul_f32 v[116:117], v[116:117], v[164:165]
    v_pk_mul_f32 v[118:119], v[118:119], v[166:167]
    v_pk_mul_f32 v[120:121], v[120:121], v[168:169]
    v_pk_mul_f32 v[122:123], v[122:123], v[170:171]
    v_pk_mul_f32 v[124:125], v[124:125], v[172:173]
    v_pk_mul_f32 v[126:127], v[126:127], v[174:175]
    v_cvt_pk_bf16_f32 v32, v144, v145
    v_cvt_pk_bf16_f32 v33, v146, v147
    v_cvt_pk_bf16_f32 v34, v148, v149
    v_cvt_pk_bf16_f32 v35, v150, v151
    v_cvt_pk_bf16_f32 v36, v152, v153
    v_cvt_pk_bf16_f32 v37, v154, v155
    v_cvt_pk_bf16_f32 v38, v156, v157
    v_cvt_pk_bf16_f32 v39, v158, v159
    s_waitcnt lgkmcnt(1)
    v_mfma_f32_32x32x16_bf16 v[144:159], a[96:99], v[72:75], v[96:111]
    v_exp_f32 v112, v112
    v_exp_f32 v113, v113
    v_exp_f32 v114, v114
    v_mfma_f32_32x32x16_bf16 v[144:159], a[100:103], v[76:79], v[144:159]
    s_waitcnt lgkmcnt(0)
    s_barrier
    v_exp_f32 v115, v115
    v_exp_f32 v116, v116
    v_exp_f32_e64 v117, v117
    v_mfma_f32_32x32x16_bf16 v[144:159], a[104:107], v[80:83], v[144:159]
    ds_read_b128 v[176:179], v15 offset:6144
    ds_read_b128 v[180:183], v15 offset:7168
    ds_read_b128 v[184:187], v15 offset:8192
    v_exp_f32 v118, v118
    v_exp_f32 v119, v119
    v_mfma_f32_32x32x16_bf16 v[144:159], a[108:111], v[84:87], v[144:159]
    ds_read_b128 v[188:191], v15 offset:9216
    ds_read_b128 v[192:195], v15 offset:10240
    ds_read_b128 v[196:199], v15 offset:11264
    v_exp_f32 v120, v120
    v_exp_f32 v121, v121
    v_mfma_f32_32x32x16_bf16 v[144:159], a[112:115], v[88:91], v[144:159]
    s_mov_b32 s88, 0xf0000f
    ds_read_b128 v[200:203], v15 offset:0
    ds_read_b128 v[204:207], v15 offset:1024
    ds_read_b128 v[208:211], v15 offset:2048
    v_exp_f32 v122, v122
    v_exp_f32 v123, v123
    v_mfma_f32_32x32x16_bf16 v[144:159], a[116:119], v[92:95], v[144:159]
    s_mov_b32 s89, 0xf0000f
    ds_read_b128 v[212:215], v15 offset:3072
    ds_read_b128 v[216:219], v15 offset:4096
    ds_read_b128 v[220:223], v15 offset:5120
    v_exp_f32 v124, v124
    v_exp_f32 v125, v125
    v_exp_f32 v126, v126
    v_exp_f32 v127, v127
    v_pk_add_f32 v[112:113], v[112:113], s[60:61]
    v_pk_add_f32 v[114:115], v[114:115], s[60:61]
    v_pk_add_f32 v[116:117], v[116:117], s[60:61]
    v_pk_add_f32 v[118:119], v[118:119], s[60:61]
    v_pk_add_f32 v[120:121], v[120:121], s[60:61]
    v_pk_add_f32 v[122:123], v[122:123], s[60:61]
    v_pk_add_f32 v[124:125], v[124:125], s[60:61]
    v_pk_add_f32 v[126:127], v[126:127], s[60:61]
    s_waitcnt lgkmcnt(0)
    v_mfma_f32_32x32x16_bf16 v[176:191], a[136:139], v[64:67], v[176:191]
    s_mov_b32 s90, 0xf0000f00
    buffer_load_dwordx4 v[40:43], v11, s[20:23], s97 offen offset:0
    v_rcp_f32 v112, v112
    v_rcp_f32 v113, v113
    v_mfma_f32_32x32x16_bf16 v[176:191], a[140:143], v[68:71], v[176:191]
    s_mov_b32 s91, 0xf0000f00
    v_rcp_f32 v114, v114
    v_mul_f32 v160, v160, v112
    v_mul_f32 v161, v161, v113
    v_rcp_f32_e64 v115, v115
    v_mfma_f32_32x32x16_bf16 v[192:207], a[144:147], v[64:67], v[192:207]
    s_mul_i32 s3, s48, 1280
    buffer_load_dwordx4 v[44:47], v11, s[20:23], s97 offen offset:16
    v_rcp_f32 v116, v116
    v_rcp_f32 v117, v117
    v_mfma_f32_32x32x16_bf16 v[192:207], a[148:151], v[68:71], v[192:207]
    s_add_u32 s3, s3, 44032
    v_rcp_f32 v118, v118
    v_rcp_f32 v119, v119
    v_rcp_f32 v120, v120
    v_mfma_f32_32x32x16_bf16 v[208:223], a[152:155], v[64:67], v[208:223]
    s_movk_i32 s100, 320
    buffer_load_dwordx4 v[48:51], v11, s[20:23], s97 offen offset:32
    v_rcp_f32 v121, v121
    v_rcp_f32 v122, v122
    v_rcp_f32 v123, v123
    v_mfma_f32_32x32x16_bf16 v[208:223], a[156:159], v[68:71], v[208:223]
    s_add_u32 s101, s3, 256
    v_rcp_f32 v124, v124
    v_rcp_f32 v125, v125
    v_rcp_f32 v126, v126
    v_rcp_f32_e64 v127, v127
    v_pk_mul_f32 v[162:163], v[162:163], v[114:115]
    v_pk_mul_f32 v[164:165], v[164:165], v[116:117]
    v_pk_mul_f32 v[166:167], v[166:167], v[118:119]
    v_pk_mul_f32 v[168:169], v[168:169], v[120:121]
    v_pk_mul_f32 v[170:171], v[170:171], v[122:123]
    v_pk_mul_f32 v[172:173], v[172:173], v[124:125]
    v_pk_mul_f32 v[174:175], v[174:175], v[126:127]
    v_pk_fma_f32 v[112:113], v[128:129], v[128:129], s[58:59] neg_lo:[1,0,0] neg_hi:[1,0,0]
    v_pk_fma_f32 v[114:115], v[130:131], v[130:131], s[58:59] neg_lo:[1,0,0] neg_hi:[1,0,0]
    v_pk_fma_f32 v[116:117], v[132:133], v[132:133], s[58:59] neg_lo:[1,0,0] neg_hi:[1,0,0]
    v_pk_fma_f32 v[118:119], v[134:135], v[134:135], s[58:59] neg_lo:[1,0,0] neg_hi:[1,0,0]
    v_pk_fma_f32 v[120:121], v[136:137], v[136:137], s[58:59] neg_lo:[1,0,0] neg_hi:[1,0,0]
    v_pk_fma_f32 v[122:123], v[138:139], v[138:139], s[58:59] neg_lo:[1,0,0] neg_hi:[1,0,0]
    v_pk_fma_f32 v[124:125], v[140:141], v[140:141], s[58:59] neg_lo:[1,0,0] neg_hi:[1,0,0]
    v_pk_fma_f32 v[126:127], v[142:143], v[142:143], s[58:59] neg_lo:[1,0,0] neg_hi:[1,0,0]
    v_pk_mul_f32 v[112:113], v[112:113], v[128:129]
    v_pk_mul_f32 v[114:115], v[114:115], v[130:131]
    v_pk_mul_f32 v[116:117], v[116:117], v[132:133]
    v_pk_mul_f32 v[118:119], v[118:119], v[134:135]
    v_pk_mul_f32 v[120:121], v[120:121], v[136:137]
    v_pk_mul_f32 v[122:123], v[122:123], v[138:139]
    v_pk_mul_f32 v[124:125], v[124:125], v[140:141]
    v_pk_mul_f32 v[126:127], v[126:127], v[142:143]
    v_mfma_f32_32x32x16_bf16 v[176:191], a[160:163], v[32:35], v[176:191]
    buffer_load_dwordx4 v[52:55], v11, s[20:23], s98 offen offset:0
    v_cvt_pk_bf16_f32 v64, v160, v161
    v_cvt_pk_bf16_f32 v65, v162, v163
    v_cvt_pk_bf16_f32 v66, v164, v165
    v_cvt_pk_bf16_f32 v67, v166, v167
    v_cvt_pk_bf16_f32 v68, v168, v169
    v_cvt_pk_bf16_f32 v69, v170, v171
    v_mfma_f32_32x32x16_bf16 v[176:191], a[164:167], v[36:39], v[176:191]
    v_cvt_pk_bf16_f32 v70, v172, v173
    v_cvt_pk_bf16_f32 v71, v174, v175
    v_exp_f32 v112, v112
    v_exp_f32 v113, v113
    v_mfma_f32_32x32x16_bf16 v[192:207], a[168:171], v[32:35], v[192:207]
    buffer_load_dwordx4 v[56:59], v11, s[20:23], s98 offen offset:16
    v_exp_f32 v114, v114
    v_exp_f32 v115, v115
    v_exp_f32 v116, v116
    v_mfma_f32_32x32x16_bf16 v[192:207], a[172:175], v[36:39], v[192:207]
    v_exp_f32 v117, v117
    v_exp_f32 v118, v118
    v_exp_f32 v119, v119
    v_mfma_f32_32x32x16_bf16 v[208:223], a[176:179], v[32:35], v[208:223]
    buffer_load_dwordx4 v[60:63], v11, s[20:23], s98 offen offset:32
    v_exp_f32 v120, v120
    v_exp_f32 v121, v121
    v_exp_f32 v122, v122
    v_mfma_f32_32x32x16_bf16 v[208:223], a[180:183], v[36:39], v[208:223]
    v_exp_f32 v123, v123
    v_exp_f32 v124, v124
    v_exp_f32 v125, v125
    v_exp_f32 v126, v126
    v_exp_f32 v127, v127
    v_pk_add_f32 v[112:113], v[112:113], s[60:61]
    v_pk_add_f32 v[114:115], v[114:115], s[60:61]
    v_pk_add_f32 v[116:117], v[116:117], s[60:61]
    v_pk_add_f32 v[118:119], v[118:119], s[60:61]
    v_pk_add_f32 v[120:121], v[120:121], s[60:61]
    v_pk_add_f32 v[122:123], v[122:123], s[60:61]
    v_pk_add_f32 v[124:125], v[124:125], s[60:61]
    v_pk_add_f32 v[126:127], v[126:127], s[60:61]
    v_mfma_f32_32x32x16_bf16 v[176:191], a[184:187], v[64:67], v[176:191]
    ds_read_b128 v[96:99], v4 offset:512
    ds_read_b128 v[100:103], v4 offset:544
    v_rcp_f32 v112, v112
    v_rcp_f32 v113, v113
    v_mfma_f32_32x32x16_bf16 v[176:191], a[188:191], v[68:71], v[176:191]
    ds_read_b128 v[104:107], v4 offset:576
    ds_read_b128 v[108:111], v4 offset:608
    v_rcp_f32 v114, v114
    v_mul_f32 v128, v128, v112
    v_mul_f32 v129, v129, v113
    v_mfma_f32_32x32x16_bf16 v[192:207], a[192:195], v[64:67], v[192:207]
    v_rcp_f32 v115, v115
    v_rcp_f32 v116, v116
    v_rcp_f32 v117, v117
    v_mfma_f32_32x32x16_bf16 v[192:207], a[196:199], v[68:71], v[192:207]
    v_rcp_f32 v118, v118
    v_rcp_f32 v119, v119
    v_rcp_f32 v120, v120
    v_mfma_f32_32x32x16_bf16 v[208:223], a[200:203], v[64:67], v[208:223]
    v_rcp_f32 v121, v121
    v_rcp_f32 v122, v122
    v_rcp_f32 v123, v123
    v_mfma_f32_32x32x16_bf16 v[208:223], a[204:207], v[68:71], v[208:223]
    s_waitcnt lgkmcnt(0)
    v_rcp_f32 v124, v124
    v_rcp_f32 v125, v125
    v_rcp_f32 v126, v126
    v_rcp_f32_e64 v127, v127
    v_pk_mul_f32 v[130:131], v[130:131], v[114:115]
    v_pk_mul_f32 v[132:133], v[132:133], v[116:117]
    v_pk_mul_f32 v[134:135], v[134:135], v[118:119]
    v_pk_mul_f32 v[136:137], v[136:137], v[120:121]
    v_pk_mul_f32 v[138:139], v[138:139], v[122:123]
    v_pk_mul_f32 v[140:141], v[140:141], v[124:125]
    v_pk_mul_f32 v[142:143], v[142:143], v[126:127]
    v_pk_fma_f32 v[112:113], v[144:145], v[144:145], s[58:59] neg_lo:[1,0,0] neg_hi:[1,0,0]
    v_pk_fma_f32 v[114:115], v[146:147], v[146:147], s[58:59] neg_lo:[1,0,0] neg_hi:[1,0,0]
    v_pk_fma_f32 v[116:117], v[148:149], v[148:149], s[58:59] neg_lo:[1,0,0] neg_hi:[1,0,0]
    v_pk_fma_f32 v[118:119], v[150:151], v[150:151], s[58:59] neg_lo:[1,0,0] neg_hi:[1,0,0]
    v_pk_fma_f32 v[120:121], v[152:153], v[152:153], s[58:59] neg_lo:[1,0,0] neg_hi:[1,0,0]
    v_pk_fma_f32 v[122:123], v[154:155], v[154:155], s[58:59] neg_lo:[1,0,0] neg_hi:[1,0,0]
    v_pk_fma_f32 v[124:125], v[156:157], v[156:157], s[58:59] neg_lo:[1,0,0] neg_hi:[1,0,0]
    v_pk_fma_f32 v[126:127], v[158:159], v[158:159], s[58:59] neg_lo:[1,0,0] neg_hi:[1,0,0]
    v_pk_mul_f32 v[112:113], v[112:113], v[144:145]
    v_pk_mul_f32 v[114:115], v[114:115], v[146:147]
    v_pk_mul_f32 v[116:117], v[116:117], v[148:149]
    v_pk_mul_f32 v[118:119], v[118:119], v[150:151]
    v_pk_mul_f32 v[120:121], v[120:121], v[152:153]
    v_pk_mul_f32 v[122:123], v[122:123], v[154:155]
    v_pk_mul_f32 v[124:125], v[124:125], v[156:157]
    v_pk_mul_f32 v[126:127], v[126:127], v[158:159]
    v_mfma_f32_32x32x16_bf16 v[160:175], a[120:123], v[72:75], v[96:111]
    v_add_u32_e64 v13, s75, v13
    v_cvt_pk_bf16_f32 v64, v128, v129
    v_cvt_pk_bf16_f32 v65, v130, v131
    v_cvt_pk_bf16_f32 v66, v132, v133
    v_cvt_pk_bf16_f32 v67, v134, v135
    v_cvt_pk_bf16_f32 v68, v136, v137
    v_mfma_f32_32x32x16_bf16 v[160:175], a[124:127], v[76:79], v[160:175]
    ds_read_b128 v[72:75], v13 offset:0
    v_cvt_pk_bf16_f32 v69, v138, v139
    v_cvt_pk_bf16_f32 v70, v140, v141
    v_cvt_pk_bf16_f32 v71, v142, v143
    v_exp_f32 v112, v112
    v_mfma_f32_32x32x16_bf16 v[160:175], a[128:131], v[80:83], v[160:175]
    ds_read_b128 v[76:79], v13 offset:6304
    v_exp_f32 v113, v113
    v_exp_f32 v114, v114
    v_exp_f32 v115, v115
    v_mfma_f32_32x32x16_bf16 v[160:175], a[132:135], v[84:87], v[160:175]
    ds_read_b128 v[80:83], v13 offset:12608
    v_exp_f32 v116, v116
    v_exp_f32 v117, v117
    v_exp_f32 v118, v118
    v_exp_f32 v119, v119
    v_mfma_f32_32x32x16_bf16 v[160:175], v[248:251], v[88:91], v[160:175]
    ds_read_b128 v[84:87], v13 offset:18912
    v_exp_f32 v120, v120
    v_exp_f32 v121, v121
    v_exp_f32 v122, v122
    v_exp_f32 v123, v123
    v_mfma_f32_32x32x16_bf16 v[160:175], v[252:255], v[92:95], v[160:175]
    ds_read_b128 v[88:91], v13 offset:25216
    v_exp_f32 v124, v124
    v_exp_f32 v125, v125
    v_exp_f32 v126, v126
    v_exp_f32 v127, v127
    v_pk_add_f32 v[112:113], v[112:113], s[60:61]
    v_pk_add_f32 v[114:115], v[114:115], s[60:61]
    v_pk_add_f32 v[116:117], v[116:117], s[60:61]
    v_pk_add_f32 v[118:119], v[118:119], s[60:61]
    v_pk_add_f32 v[120:121], v[120:121], s[60:61]
    v_pk_add_f32 v[122:123], v[122:123], s[60:61]
    v_pk_add_f32 v[124:125], v[124:125], s[60:61]
    v_pk_add_f32 v[126:127], v[126:127], s[60:61]
    v_mfma_f32_32x32x16_bf16 v[176:191], a[208:211], v[64:67], v[176:191]
    ds_read_b128 v[92:95], v13 offset:31520
    ds_read_b128 v[96:99], v3 offset:0
    ds_read_b128 v[100:103], v3 offset:32
    v_and_b32 v36, 48, v1
    v_add_u32 v37, v30, v36
    v_add_u32_e64 v30, 64, v30
    v_mfma_f32_32x32x16_bf16 v[176:191], a[212:215], v[68:71], v[176:191]
    ds_read_b128 v[104:107], v3 offset:64
    ds_read_b128 v[108:111], v3 offset:96
    v_cndmask_b32 v24, v30, v37, s[88:89]
    v_cndmask_b32 v25, v30, v37, s[90:91]
    v_rcp_f32 v112, v112
    v_mfma_f32_32x32x16_bf16 v[192:207], a[216:219], v[64:67], v[192:207]
    v_rcp_f32 v113, v113
    v_rcp_f32 v114, v114
    v_mul_f32 v144, v144, v112
    v_mul_f32 v145, v145, v113
    v_mfma_f32_32x32x16_bf16 v[192:207], a[220:223], v[68:71], v[192:207]
    v_rcp_f32 v115, v115
    v_rcp_f32 v116, v116
    v_rcp_f32 v117, v117
    v_mfma_f32_32x32x16_bf16 v[208:223], a[224:227], v[64:67], v[208:223]
    v_rcp_f32 v118, v118
    v_rcp_f32 v119, v119
    v_rcp_f32 v120, v120
    v_mfma_f32_32x32x16_bf16 v[208:223], a[228:231], v[68:71], v[208:223]
    s_waitcnt lgkmcnt(0)
    v_rcp_f32 v121, v121
    v_rcp_f32 v122, v122
    v_rcp_f32 v123, v123
    v_rcp_f32 v124, v124
    v_rcp_f32 v125, v125
    v_rcp_f32 v126, v126
    v_rcp_f32_e64 v127, v127
    v_pk_mul_f32 v[146:147], v[146:147], v[114:115]
    v_pk_mul_f32 v[148:149], v[148:149], v[116:117]
    v_pk_mul_f32 v[150:151], v[150:151], v[118:119]
    v_pk_mul_f32 v[152:153], v[152:153], v[120:121]
    v_pk_mul_f32 v[154:155], v[154:155], v[122:123]
    v_pk_mul_f32 v[156:157], v[156:157], v[124:125]
    v_pk_mul_f32 v[158:159], v[158:159], v[126:127]
    v_pk_fma_f32 v[112:113], v[160:161], v[160:161], s[58:59] neg_lo:[1,0,0] neg_hi:[1,0,0]
    v_pk_fma_f32 v[114:115], v[162:163], v[162:163], s[58:59] neg_lo:[1,0,0] neg_hi:[1,0,0]
    v_pk_fma_f32 v[116:117], v[164:165], v[164:165], s[58:59] neg_lo:[1,0,0] neg_hi:[1,0,0]
    v_pk_fma_f32 v[118:119], v[166:167], v[166:167], s[58:59] neg_lo:[1,0,0] neg_hi:[1,0,0]
    v_pk_fma_f32 v[120:121], v[168:169], v[168:169], s[58:59] neg_lo:[1,0,0] neg_hi:[1,0,0]
    v_pk_fma_f32 v[122:123], v[170:171], v[170:171], s[58:59] neg_lo:[1,0,0] neg_hi:[1,0,0]
    v_pk_fma_f32 v[124:125], v[172:173], v[172:173], s[58:59] neg_lo:[1,0,0] neg_hi:[1,0,0]
    v_pk_fma_f32 v[126:127], v[174:175], v[174:175], s[58:59] neg_lo:[1,0,0] neg_hi:[1,0,0]
    v_pk_mul_f32 v[112:113], v[112:113], v[160:161]
    v_pk_mul_f32 v[114:115], v[114:115], v[162:163]
    v_pk_mul_f32 v[116:117], v[116:117], v[164:165]
    v_pk_mul_f32 v[118:119], v[118:119], v[166:167]
    v_pk_mul_f32 v[120:121], v[120:121], v[168:169]
    v_pk_mul_f32 v[122:123], v[122:123], v[170:171]
    v_pk_mul_f32 v[124:125], v[124:125], v[172:173]
    v_pk_mul_f32 v[126:127], v[126:127], v[174:175]
    v_mfma_f32_32x32x16_bf16 v[128:143], a[0:3], v[72:75], v[96:111]
    v_cvt_pk_bf16_f32 v64, v144, v145
    v_cvt_pk_bf16_f32 v65, v146, v147
    v_cvt_pk_bf16_f32 v66, v148, v149
    v_cvt_pk_bf16_f32 v67, v150, v151
    v_cvt_pk_bf16_f32 v68, v152, v153
    v_cvt_pk_bf16_f32 v69, v154, v155
    v_mfma_f32_32x32x16_bf16 v[128:143], a[4:7], v[76:79], v[128:143]
    v_cvt_pk_bf16_f32 v70, v156, v157
    v_cvt_pk_bf16_f32 v71, v158, v159
    v_exp_f32 v112, v112
    v_exp_f32 v113, v113
    v_mfma_f32_32x32x16_bf16 v[128:143], a[8:11], v[80:83], v[128:143]
    v_exp_f32 v114, v114
    v_exp_f32 v115, v115
    v_exp_f32 v116, v116
    v_mfma_f32_32x32x16_bf16 v[128:143], a[12:15], v[84:87], v[128:143]
    v_exp_f32 v117, v117
    v_exp_f32 v118, v118
    v_exp_f32 v119, v119
    v_mfma_f32_32x32x16_bf16 v[128:143], a[16:19], v[88:91], v[128:143]
L_pad4:
    s_cbranch_execz L_back
    v_exp_f32 v120, v120
    v_exp_f32 v121, v121
    v_exp_f32 v122, v122
    v_mfma_f32_32x32x16_bf16 v[128:143], a[20:23], v[92:95], v[128:143]
    v_exp_f32 v123, v123
    v_exp_f32 v124, v124
    v_exp_f32 v125, v125
    v_exp_f32 v126, v126
    v_exp_f32_e64 v127, v127
    v_pk_add_f32 v[112:113], v[112:113], s[60:61]
    v_pk_add_f32 v[114:115], v[114:115], s[60:61]
    v_pk_add_f32 v[116:117], v[116:117], s[60:61]
    v_pk_add_f32 v[118:119], v[118:119], s[60:61]
    v_pk_add_f32 v[120:121], v[120:121], s[60:61]
    v_pk_add_f32 v[122:123], v[122:123], s[60:61]
    v_pk_add_f32 v[124:125], v[124:125], s[60:61]
    v_pk_add_f32 v[126:127], v[126:127], s[60:61]
    v_mfma_f32_32x32x16_bf16 v[176:191], a[232:235], v[64:67], v[176:191]
    ds_read_b128 v[96:99], v4 offset:0
    ds_read_b128 v[100:103], v4 offset:32
    v_rcp_f32 v112, v112
    v_rcp_f32 v113, v113
    v_mfma_f32_32x32x16_bf16 v[176:191], a[236:239], v[68:71], v[176:191]
    ds_read_b128 v[104:107], v4 offset:64
    ds_read_b128 v[108:111], v4 offset:96
    v_rcp_f32 v114, v114
    v_mul_f32 v160, v160, v112
    v_mul_f32 v161, v161, v113
    v_mfma_f32_32x32x16_bf16 v[192:207], a[240:243], v[64:67], v[192:207]
    v_rcp_f32 v115, v115
    v_rcp_f32 v116, v116
    v_rcp_f32 v117, v117
    v_mfma_f32_32x32x16_bf16 v[192:207], a[244:247], v[68:71], v[192:207]
    v_rcp_f32 v118, v118
    v_rcp_f32 v119, v119
    v_rcp_f32 v120, v120
    v_mfma_f32_32x32x16_bf16 v[208:223], a[248:251], v[64:67], v[208:223]
    v_rcp_f32 v121, v121
    v_rcp_f32 v122, v122
    v_rcp_f32 v123, v123
    v_mfma_f32_32x32x16_bf16 v[208:223], a[252:255], v[68:71], v[208:223]
    s_waitcnt lgkmcnt(0)
    v_rcp_f32 v124, v124
    v_rcp_f32 v125, v125
    v_rcp_f32 v126, v126
    v_rcp_f32_e64 v127, v127
    v_pk_mul_f32 v[162:163], v[162:163], v[114:115]
    v_pk_mul_f32 v[164:165], v[164:165], v[116:117]
    v_pk_mul_f32 v[166:167], v[166:167], v[118:119]
    v_pk_mul_f32 v[168:169], v[168:169], v[120:121]
    v_pk_mul_f32 v[170:171], v[170:171], v[122:123]
    v_pk_mul_f32 v[172:173], v[172:173], v[124:125]
    v_pk_mul_f32 v[174:175], v[174:175], v[126:127]
    v_pk_fma_f32 v[112:113], v[128:129], v[128:129], s[58:59] neg_lo:[1,0,0] neg_hi:[1,0,0]
    v_pk_fma_f32 v[114:115], v[130:131], v[130:131], s[58:59] neg_lo:[1,0,0] neg_hi:[1,0,0]
    v_pk_fma_f32 v[116:117], v[132:133], v[132:133], s[58:59] neg_lo:[1,0,0] neg_hi:[1,0,0]
    v_pk_fma_f32 v[118:119], v[134:135], v[134:135], s[58:59] neg_lo:[1,0,0] neg_hi:[1,0,0]
    v_pk_fma_f32 v[120:121], v[136:137], v[136:137], s[58:59] neg_lo:[1,0,0] neg_hi:[1,0,0]
    v_pk_fma_f32 v[122:123], v[138:139], v[138:139], s[58:59] neg_lo:[1,0,0] neg_hi:[1,0,0]
    v_pk_fma_f32 v[124:125], v[140:141], v[140:141], s[58:59] neg_lo:[1,0,0] neg_hi:[1,0,0]
    v_pk_fma_f32 v[126:127], v[142:143], v[142:143], s[58:59] neg_lo:[1,0,0] neg_hi:[1,0,0]
    v_pk_mul_f32 v[112:113], v[112:113], v[128:129]
    v_pk_mul_f32 v[114:115], v[114:115], v[130:131]
    v_pk_mul_f32 v[116:117], v[116:117], v[132:133]
    v_pk_mul_f32 v[118:119], v[118:119], v[134:135]
    v_pk_mul_f32 v[120:121], v[120:121], v[136:137]
    v_pk_mul_f32 v[122:123], v[122:123], v[138:139]
    v_pk_mul_f32 v[124:125], v[124:125], v[140:141]
    v_pk_mul_f32 v[126:127], v[126:127], v[142:143]
    v_mfma_f32_32x32x16_bf16 v[144:159], a[24:27], v[72:75], v[96:111]
    ds_read_b128 v[32:35], v5 offset:704
    v_cvt_pk_bf16_f32 v64, v160, v161
    v_cvt_pk_bf16_f32 v65, v162, v163
    v_cvt_pk_bf16_f32 v66, v164, v165
    v_cvt_pk_bf16_f32 v67, v166, v167
    v_cvt_pk_bf16_f32 v68, v168, v169
    v_mfma_f32_32x32x16_bf16 v[144:159], a[28:31], v[76:79], v[144:159]
    ds_read_b128 v[36:39], v5 offset:720
    v_cvt_pk_bf16_f32 v69, v170, v171
    v_cvt_pk_bf16_f32 v70, v172, v173
    v_cvt_pk_bf16_f32 v71, v174, v175
    v_exp_f32 v112, v112
    v_mfma_f32_32x32x16_bf16 v[144:159], a[32:35], v[80:83], v[144:159]
    ds_read_b128 v[96:99], v5 offset:640
    v_exp_f32 v113, v113
    v_exp_f32 v114, v114
    v_exp_f32 v115, v115
    v_mfma_f32_32x32x16_bf16 v[144:159], a[36:39], v[84:87], v[144:159]
    ds_read_b128 v[100:103], v5 offset:656
    v_exp_f32 v116, v116
    v_exp_f32 v117, v117
    v_exp_f32 v118, v118
    v_exp_f32 v119, v119
    v_mfma_f32_32x32x16_bf16 v[144:159], a[40:43], v[88:91], v[144:159]
    ds_read_b128 v[104:107], v5 offset:672
    v_exp_f32 v120, v120
    v_exp_f32 v121, v121
    v_exp_f32 v122, v122
    v_exp_f32 v123, v123
    v_mfma_f32_32x32x16_bf16 v[144:159], a[44:47], v[92:95], v[144:159]
    ds_read_b128 v[108:111], v5 offset:688
    v_exp_f32 v124, v124
    v_exp_f32 v125, v125
    v_exp_f32 v126, v126
    v_exp_f32 v127, v127
    v_pk_add_f32 v[112:113], v[112:113], s[60:61]
    v_pk_add_f32 v[114:115], v[114:115], s[60:61]
    v_pk_add_f32 v[116:117], v[116:117], s[60:61]
    v_pk_add_f32 v[118:119], v[118:119], s[60:61]
    v_pk_add_f32 v[120:121], v[120:121], s[60:61]
    v_pk_add_f32 v[122:123], v[122:123], s[60:61]
    v_pk_add_f32 v[124:125], v[124:125], s[60:61]
    v_pk_add_f32 v[126:127], v[126:127], s[60:61]
    v_mfma_f32_32x32x16_bf16 v[176:191], v[224:227], v[64:67], v[176:191]
    ds_read_b128 v[160:163], v5 offset:576
    v_rcp_f32 v112, v112
    v_rcp_f32 v113, v113
    v_mfma_f32_32x32x16_bf16 v[176:191], v[228:231], v[68:71], v[176:191]
    ds_read_b128 v[164:167], v5 offset:592
    v_rcp_f32 v114, v114
    v_rcp_f32 v115, v115
    v_mfma_f32_32x32x16_bf16 v[192:207], v[232:235], v[64:67], v[192:207]
    ds_read_b128 v[168:171], v5 offset:608
    v_rcp_f32 v116, v116
    v_rcp_f32 v117, v117
    v_rcp_f32 v118, v118
    v_mfma_f32_32x32x16_bf16 v[192:207], v[236:239], v[68:71], v[192:207]
    ds_read_b128 v[172:175], v5 offset:624
    v_rcp_f32 v119, v119
    v_rcp_f32 v120, v120
    v_rcp_f32 v121, v121
    v_mfma_f32_32x32x16_bf16 v[208:223], v[240:243], v[64:67], v[208:223]
    v_rcp_f32 v122, v122
    v_rcp_f32 v123, v123
    v_rcp_f32 v124, v124
    v_mfma_f32_32x32x16_bf16 v[208:223], v[244:247], v[68:71], v[208:223]
    s_waitcnt lgkmcnt(0)
    ds_read_b128 v[64:67], v5 offset:736
    ds_read_b128 v[68:71], v5 offset:752
    v_rcp_f32 v125, v125
    v_rcp_f32 v126, v126
    v_rcp_f32_e64 v127, v127
    v_pk_mul_f32 v[176:177], v[176:177], v[160:161]
    v_pk_mul_f32 v[178:179], v[178:179], v[162:163]
    v_pk_mul_f32 v[180:181], v[180:181], v[164:165]
    v_pk_mul_f32 v[182:183], v[182:183], v[166:167]
    v_pk_mul_f32 v[184:185], v[184:185], v[168:169]
    v_pk_mul_f32 v[186:187], v[186:187], v[170:171]
    v_pk_mul_f32 v[188:189], v[188:189], v[172:173]
    v_pk_mul_f32 v[190:191], v[190:191], v[174:175]
    v_pk_mul_f32 v[192:193], v[192:193], v[96:97]
    v_pk_mul_f32 v[194:195], v[194:195], v[98:99]
    v_pk_mul_f32 v[196:197], v[196:197], v[100:101]
    v_pk_mul_f32 v[198:199], v[198:199], v[102:103]
    v_pk_mul_f32 v[200:201], v[200:201], v[104:105]
    v_pk_mul_f32 v[202:203], v[202:203], v[106:107]
    v_pk_mul_f32 v[204:205], v[204:205], v[108:109]
    v_pk_mul_f32 v[206:207], v[206:207], v[110:111]
    v_pk_mul_f32 v[128:129], v[128:129], v[112:113]
    v_pk_mul_f32 v[130:131], v[130:131], v[114:115]
    v_pk_mul_f32 v[132:133], v[132:133], v[116:117]
    v_pk_mul_f32 v[134:135], v[134:135], v[118:119]
    v_pk_mul_f32 v[136:137], v[136:137], v[120:121]
    v_pk_mul_f32 v[138:139], v[138:139], v[122:123]
    v_pk_mul_f32 v[140:141], v[140:141], v[124:125]
    v_pk_mul_f32 v[142:143], v[142:143], v[126:127]
    v_pk_fma_f32 v[112:113], v[144:145], v[144:145], s[58:59] neg_lo:[1,0,0] neg_hi:[1,0,0]
    v_pk_fma_f32 v[114:115], v[146:147], v[146:147], s[58:59] neg_lo:[1,0,0] neg_hi:[1,0,0]
    v_pk_fma_f32 v[116:117], v[148:149], v[148:149], s[58:59] neg_lo:[1,0,0] neg_hi:[1,0,0]
    v_pk_fma_f32 v[118:119], v[150:151], v[150:151], s[58:59] neg_lo:[1,0,0] neg_hi:[1,0,0]
    v_pk_fma_f32 v[120:121], v[152:153], v[152:153], s[58:59] neg_lo:[1,0,0] neg_hi:[1,0,0]
    v_pk_fma_f32 v[122:123], v[154:155], v[154:155], s[58:59] neg_lo:[1,0,0] neg_hi:[1,0,0]
    v_pk_fma_f32 v[124:125], v[156:157], v[156:157], s[58:59] neg_lo:[1,0,0] neg_hi:[1,0,0]
    v_pk_fma_f32 v[126:127], v[158:159], v[158:159], s[58:59] neg_lo:[1,0,0] neg_hi:[1,0,0]
    v_pk_mul_f32 v[112:113], v[112:113], v[144:145]
    v_pk_mul_f32 v[114:115], v[114:115], v[146:147]
    v_pk_mul_f32 v[116:117], v[116:117], v[148:149]
    v_pk_mul_f32 v[118:119], v[118:119], v[150:151]
    v_pk_mul_f32 v[120:121], v[120:121], v[152:153]
    v_pk_mul_f32 v[122:123], v[122:123], v[154:155]
    v_pk_mul_f32 v[124:125], v[124:125], v[156:157]
    v_pk_mul_f32 v[126:127], v[126:127], v[158:159]
    v_pk_mul_f32 v[208:209], v[208:209], v[32:33]
    v_pk_mul_f32 v[210:211], v[210:211], v[34:35]
    v_pk_mul_f32 v[212:213], v[212:213], v[36:37]
    v_pk_mul_f32 v[214:215], v[214:215], v[38:39]
    s_waitcnt lgkmcnt(0)
    v_pk_mul_f32 v[216:217], v[216:217], v[64:65]
    v_pk_mul_f32 v[218:219], v[218:219], v[66:67]
    v_pk_mul_f32 v[220:221], v[220:221], v[68:69]
    v_pk_mul_f32 v[222:223], v[222:223], v[70:71]
    s_waitcnt vmcnt(0)
    v_mfma_f32_32x32x16_bf16 v[176:191], v[16:19], v[40:43], v[176:191]
    ds_read_b128 v[96:99], v3 offset:256
    ds_read_b128 v[100:103], v3 offset:288
    ds_read_b128 v[104:107], v3 offset:320
    ds_read_b128 v[108:111], v3 offset:352
    v_cvt_pk_bf16_f32 v64, v128, v129
    v_cvt_pk_bf16_f32 v65, v130, v131
    v_mfma_f32_32x32x16_bf16 v[176:191], v[20:23], v[44:47], v[176:191]
    v_cvt_pk_bf16_f32 v66, v132, v133
    v_cvt_pk_bf16_f32 v67, v134, v135
    v_cvt_pk_bf16_f32 v68, v136, v137
    v_cvt_pk_bf16_f32 v69, v138, v139
    v_cvt_pk_bf16_f32 v70, v140, v141
    v_mfma_f32_32x32x16_bf16 v[192:207], v[16:19], v[48:51], v[192:207]
    v_cvt_pk_bf16_f32 v71, v142, v143
    v_exp_f32 v112, v112
    v_exp_f32 v113, v113
    v_mfma_f32_32x32x16_bf16 v[192:207], v[20:23], v[52:55], v[192:207]
    v_exp_f32 v114, v114
    v_exp_f32 v115, v115
    v_exp_f32_e64 v116, v116
    v_mfma_f32_32x32x16_bf16 v[208:223], v[16:19], v[56:59], v[208:223]
    v_cvt_pk_bf16_f32 v176, v176, v177
    v_cvt_pk_bf16_f32 v177, v178, v179
    v_cvt_pk_bf16_f32 v178, v180, v181
    v_cvt_pk_bf16_f32 v179, v182, v183
    v_cvt_pk_bf16_f32 v180, v184, v185
    v_cvt_pk_bf16_f32 v181, v186, v187
    v_mfma_f32_32x32x16_bf16 v[208:223], v[20:23], v[60:63], v[208:223]
    s_waitcnt lgkmcnt(0)
    v_cvt_pk_bf16_f32 v182, v188, v189
    v_cvt_pk_bf16_f32 v183, v190, v191
    v_exp_f32 v117, v117
    v_exp_f32_e64 v118, v118
    v_mfma_f32_32x32x16_bf16 v[160:175], a[48:51], v[72:75], v[96:111]
    ds_write_b128 v6, v[176:179] offset:0
    v_cvt_pk_bf16_f32 v192, v192, v193
    v_cvt_pk_bf16_f32 v193, v194, v195
    v_cvt_pk_bf16_f32 v194, v196, v197
    v_cvt_pk_bf16_f32 v195, v198, v199
    v_cvt_pk_bf16_f32 v196, v200, v201
    v_cvt_pk_bf16_f32 v197, v202, v203
    v_exp_f32_e64 v119, v119
    v_mfma_f32_32x32x16_bf16 v[160:175], a[52:55], v[76:79], v[160:175]
    ds_write_b128 v6, v[180:183] offset:16
    v_cvt_pk_bf16_f32 v198, v204, v205
    v_cvt_pk_bf16_f32 v199, v206, v207
    v_exp_f32 v120, v120
    v_exp_f32 v121, v121
    v_mfma_f32_32x32x16_bf16 v[160:175], a[56:59], v[80:83], v[160:175]
    ds_read_b128 v[176:179], v5 offset:0
    ds_read_b128 v[180:183], v5 offset:16
    ds_write_b128 v6, v[192:195] offset:32
    v_cvt_pk_bf16_f32 v208, v208, v209
    v_cvt_pk_bf16_f32 v209, v210, v211
    v_cvt_pk_bf16_f32 v210, v212, v213
    v_cvt_pk_bf16_f32 v211, v214, v215
    v_cvt_pk_bf16_f32 v212, v216, v217
    v_cvt_pk_bf16_f32 v213, v218, v219
    v_mfma_f32_32x32x16_bf16 v[160:175], a[60:63], v[84:87], v[160:175]
    ds_read_b128 v[184:187], v5 offset:32
    ds_read_b128 v[188:191], v5 offset:48
    ds_write_b128 v7, v[196:199] offset:0
    v_cvt_pk_bf16_f32 v214, v220, v221
    v_cvt_pk_bf16_f32 v215, v222, v223
    v_exp_f32 v122, v122
    v_exp_f32 v123, v123
    v_exp_f32 v124, v124
    v_mfma_f32_32x32x16_bf16 v[160:175], a[64:67], v[88:91], v[160:175]
    ds_write_b128 v7, v[208:211] offset:16
    v_exp_f32 v125, v125
    v_exp_f32 v126, v126
    v_exp_f32 v127, v127
    v_mfma_f32_32x32x16_bf16 v[160:175], a[68:71], v[92:95], v[160:175]
    ds_read_b128 v[192:195], v5 offset:64
    ds_read_b128 v[196:199], v5 offset:80
    ds_write_b128 v7, v[212:215] offset:32
    v_mov_b64 v[200:201], 0
    v_mov_b64 v[202:203], 0
    v_mov_b64 v[204:205], 0
    v_mov_b64 v[206:207], 0
    v_pk_add_f32 v[112:113], v[112:113], s[60:61]
    v_pk_add_f32 v[114:115], v[114:115], s[60:61]
    v_pk_add_f32 v[116:117], v[116:117], s[60:61]
    v_pk_add_f32 v[118:119], v[118:119], s[60:61]
    v_pk_add_f32 v[120:121], v[120:121], s[60:61]
    v_pk_add_f32 v[122:123], v[122:123], s[60:61]
    v_pk_add_f32 v[124:125], v[124:125], s[60:61]
    v_pk_add_f32 v[126:127], v[126:127], s[60:61]
    s_waitcnt lgkmcnt(1)
    v_mfma_f32_32x32x16_bf16 v[176:191], a[136:139], v[64:67], v[176:191]
    ds_read_b128 v[40:43], v8 offset:0
    v_and_b32 v36, 48, v1
    v_lshlrev_b32 v36, 2, v36
    v_mov_b32 v37, 0x100
    v_cndmask_b32 v38, v37, v36, s[88:89]
    v_lshrrev_b32 v37, 9, v1
    v_mfma_f32_32x32x16_bf16 v[176:191], a[140:143], v[68:71], v[176:191]
    ds_read_b128 v[44:47], v9 offset:0
    v_lshl_add_u32 v38, v37, 3, v38
    v_rcp_f32 v112, v112
    v_rcp_f32 v113, v113
    v_mfma_f32_32x32x16_bf16 v[192:207], a[144:147], v[64:67], v[192:207]
    ds_read_b128 v[48:51], v10 offset:0
    ds_read_b128 v[96:99], v4 offset:256
    v_rcp_f32 v114, v114
    v_rcp_f32 v115, v115
    v_mfma_f32_32x32x16_bf16 v[192:207], a[148:151], v[68:71], v[192:207]
    ds_read_b128 v[52:55], v8 offset:3328
    ds_read_b128 v[100:103], v4 offset:288
    v_rcp_f32 v116, v116
    v_rcp_f32 v117, v117
    v_mfma_f32_32x32x16_bf16 v[208:223], a[152:155], v[64:67], 0
    ds_read_b128 v[56:59], v9 offset:3328
    ds_read_b128 v[104:107], v4 offset:320
    v_rcp_f32 v118, v118
    v_rcp_f32 v119, v119
    v_rcp_f32_e64 v120, v120
    v_mfma_f32_32x32x16_bf16 v[208:223], a[156:159], v[68:71], v[208:223]
    ds_read_b128 v[60:63], v10 offset:3328
    ds_read_b128 v[108:111], v4 offset:352
    v_rcp_f32 v121, v121
    v_rcp_f32 v122, v122
    v_rcp_f32 v123, v123
    v_rcp_f32 v124, v124
    v_rcp_f32 v125, v125
    v_rcp_f32 v126, v126
    v_rcp_f32_e64 v127, v127
    v_pk_mul_f32 v[144:145], v[144:145], v[112:113]
    v_pk_mul_f32 v[146:147], v[146:147], v[114:115]
    v_pk_mul_f32 v[148:149], v[148:149], v[116:117]
    v_pk_mul_f32 v[150:151], v[150:151], v[118:119]
    v_pk_mul_f32 v[152:153], v[152:153], v[120:121]
    v_pk_mul_f32 v[154:155], v[154:155], v[122:123]
    v_pk_mul_f32 v[156:157], v[156:157], v[124:125]
    v_pk_mul_f32 v[158:159], v[158:159], v[126:127]
    v_pk_fma_f32 v[112:113], v[160:161], v[160:161], s[58:59] neg_lo:[1,0,0] neg_hi:[1,0,0]
    v_pk_fma_f32 v[114:115], v[162:163], v[162:163], s[58:59] neg_lo:[1,0,0] neg_hi:[1,0,0]
    v_pk_fma_f32 v[116:117], v[164:165], v[164:165], s[58:59] neg_lo:[1,0,0] neg_hi:[1,0,0]
    v_pk_fma_f32 v[118:119], v[166:167], v[166:167], s[58:59] neg_lo:[1,0,0] neg_hi:[1,0,0]
    v_pk_fma_f32 v[120:121], v[168:169], v[168:169], s[58:59] neg_lo:[1,0,0] neg_hi:[1,0,0]
    v_pk_fma_f32 v[122:123], v[170:171], v[170:171], s[58:59] neg_lo:[1,0,0] neg_hi:[1,0,0]
    v_pk_fma_f32 v[124:125], v[172:173], v[172:173], s[58:59] neg_lo:[1,0,0] neg_hi:[1,0,0]
    v_pk_fma_f32 v[126:127], v[174:175], v[174:175], s[58:59] neg_lo:[1,0,0] neg_hi:[1,0,0]
    v_pk_mul_f32 v[112:113], v[112:113], v[160:161]
    v_pk_mul_f32 v[114:115], v[114:115], v[162:163]
    v_pk_mul_f32 v[116:117], v[116:117], v[164:165]
    v_pk_mul_f32 v[118:119], v[118:119], v[166:167]
    v_pk_mul_f32 v[120:121], v[120:121], v[168:169]
    v_pk_mul_f32 v[122:123], v[122:123], v[170:171]
    v_pk_mul_f32 v[124:125], v[124:125], v[172:173]
    v_pk_mul_f32 v[126:127], v[126:127], v[174:175]
    s_waitcnt lgkmcnt(0)
    v_mfma_f32_32x32x16_bf16 v[128:143], a[72:75], v[72:75], v[96:111]
    v_cmp_le_i32 vcc, s62, v1
    v_cvt_pk_bf16_f32 v64, v144, v145
    v_cvt_pk_bf16_f32 v65, v146, v147
    v_cndmask_b32 v14, v1, v2, vcc
    v_cvt_pk_bf16_f32 v66, v148, v149
    v_cmp_le_i32 vcc, s63, v1
    v_mfma_f32_32x32x16_bf16 v[128:143], a[76:79], v[76:79], v[128:143]
    v_cvt_pk_bf16_f32 v67, v150, v151
    v_cvt_pk_bf16_f32 v68, v152, v153
    v_cndmask_b32_e64 v15, v1, v2, vcc
    v_cvt_pk_bf16_f32 v69, v154, v155
    v_cvt_pk_bf16_f32 v70, v156, v157
    v_cvt_pk_bf16_f32 v71, v158, v159
    v_mfma_f32_32x32x16_bf16 v[128:143], a[80:83], v[80:83], v[128:143]
    v_exp_f32 v112, v112
    v_exp_f32 v113, v113
    v_exp_f32 v114, v114
    v_exp_f32 v115, v115
    v_mfma_f32_32x32x16_bf16 v[128:143], a[84:87], v[84:87], v[128:143]
    v_exp_f32 v116, v116
    v_exp_f32 v117, v117
    v_exp_f32 v118, v118
    v_mfma_f32_32x32x16_bf16 v[128:143], a[88:91], v[88:91], v[128:143]
    v_exp_f32 v119, v119
    v_exp_f32 v120, v120
    v_exp_f32 v121, v121
    v_exp_f32 v122, v122
    v_mfma_f32_32x32x16_bf16 v[128:143], a[92:95], v[92:95], v[128:143]
    v_exp_f32 v123, v123
    v_exp_f32 v124, v124
    v_exp_f32 v125, v125
    v_exp_f32 v126, v126
    v_exp_f32 v127, v127
    v_pk_add_f32 v[112:113], v[112:113], s[60:61]
    v_pk_add_f32 v[114:115], v[114:115], s[60:61]
    v_pk_add_f32 v[116:117], v[116:117], s[60:61]
    v_pk_add_f32 v[118:119], v[118:119], s[60:61]
    v_pk_add_f32 v[120:121], v[120:121], s[60:61]
    v_pk_add_f32 v[122:123], v[122:123], s[60:61]
    v_pk_add_f32 v[124:125], v[124:125], s[60:61]
    v_pk_add_f32 v[126:127], v[126:127], s[60:61]
    v_mfma_f32_32x32x16_bf16 v[176:191], a[160:163], v[64:67], v[176:191]
    buffer_store_dwordx4 v[40:43], v14, s[44:47], s71 offen offset:0 sc0 sc1
    ds_read_b128 v[96:99], v3 offset:512
    ds_read_b128 v[100:103], v3 offset:544
    v_add_u32_e64 v38, s3, v38
    v_bfe_u32 v39, v1, 4, 4
    v_mfma_f32_32x32x16_bf16 v[176:191], a[164:167], v[68:71], v[176:191]
    ds_read_b128 v[104:107], v3 offset:576
    ds_read_b128 v[108:111], v3 offset:608
    v_lshl_add_u32 v39, v39, 2, s101
    v_lshrrev_b32_e64 v37, 8, v1
    v_mad_u32_u24 v39, v37, s100, v39
    v_lshl_add_u32 v36, v37, 3, v36
    v_mfma_f32_32x32x16_bf16 v[192:207], a[168:171], v[64:67], v[192:207]
    v_rcp_f32 v112, v112
    v_rcp_f32 v113, v113
    v_rcp_f32 v114, v114
    v_mfma_f32_32x32x16_bf16 v[192:207], a[172:175], v[68:71], v[192:207]
    buffer_store_dwordx4 v[44:47], v15, s[44:47], s71 offen offset:1024 sc0 sc1
    v_rcp_f32 v115, v115
    v_rcp_f32 v116, v116
    v_rcp_f32 v117, v117
    v_mfma_f32_32x32x16_bf16 v[208:223], a[176:179], v[64:67], v[208:223]
    v_rcp_f32 v118, v118
    v_rcp_f32 v119, v119
    v_rcp_f32 v120, v120
    v_mfma_f32_32x32x16_bf16 v[208:223], a[180:183], v[68:71], v[208:223]
    s_waitcnt lgkmcnt(0)
    v_rcp_f32 v121, v121
    v_rcp_f32 v122, v122
    v_rcp_f32 v123, v123
    v_rcp_f32 v124, v124
    v_rcp_f32 v125, v125
    v_rcp_f32 v126, v126
    v_rcp_f32_e64 v127, v127
    v_pk_mul_f32 v[160:161], v[160:161], v[112:113]
    v_pk_mul_f32 v[162:163], v[162:163], v[114:115]
    v_pk_mul_f32 v[164:165], v[164:165], v[116:117]
    v_pk_mul_f32 v[166:167], v[166:167], v[118:119]
    v_pk_mul_f32 v[168:169], v[168:169], v[120:121]
    v_pk_mul_f32 v[170:171], v[170:171], v[122:123]
    v_pk_mul_f32 v[172:173], v[172:173], v[124:125]
    v_pk_mul_f32 v[174:175], v[174:175], v[126:127]
    v_pk_fma_f32 v[112:113], v[128:129], v[128:129], s[58:59] neg_lo:[1,0,0] neg_hi:[1,0,0]
    v_pk_fma_f32 v[114:115], v[130:131], v[130:131], s[58:59] neg_lo:[1,0,0] neg_hi:[1,0,0]
    v_pk_fma_f32 v[116:117], v[132:133], v[132:133], s[58:59] neg_lo:[1,0,0] neg_hi:[1,0,0]
    v_pk_fma_f32 v[118:119], v[134:135], v[134:135], s[58:59] neg_lo:[1,0,0] neg_hi:[1,0,0]
    v_pk_fma_f32 v[120:121], v[136:137], v[136:137], s[58:59] neg_lo:[1,0,0] neg_hi:[1,0,0]
    v_pk_fma_f32 v[122:123], v[138:139], v[138:139], s[58:59] neg_lo:[1,0,0] neg_hi:[1,0,0]
    v_pk_fma_f32 v[124:125], v[140:141], v[140:141], s[58:59] neg_lo:[1,0,0] neg_hi:[1,0,0]
    v_pk_fma_f32 v[126:127], v[142:143], v[142:143], s[58:59] neg_lo:[1,0,0] neg_hi:[1,0,0]
    v_pk_mul_f32 v[112:113], v[112:113], v[128:129]
    v_pk_mul_f32 v[114:115], v[114:115], v[130:131]
    v_pk_mul_f32 v[116:117], v[116:117], v[132:133]
    v_pk_mul_f32 v[118:119], v[118:119], v[134:135]
    v_pk_mul_f32 v[120:121], v[120:121], v[136:137]
    v_pk_mul_f32 v[122:123], v[122:123], v[138:139]
    v_pk_mul_f32 v[124:125], v[124:125], v[140:141]
    v_pk_mul_f32 v[126:127], v[126:127], v[142:143]
    v_mfma_f32_32x32x16_bf16 v[144:159], a[96:99], v[72:75], v[96:111]
    v_cmp_le_i32 vcc, s64, v1
    v_cvt_pk_bf16_f32 v64, v160, v161
    v_cvt_pk_bf16_f32 v65, v162, v163
    v_cndmask_b32 v14, v1, v2, vcc
    v_cvt_pk_bf16_f32 v66, v164, v165
    v_cmp_le_i32_e64 vcc, s65, v1
    v_mfma_f32_32x32x16_bf16 v[144:159], a[100:103], v[76:79], v[144:159]
    v_cvt_pk_bf16_f32 v67, v166, v167
    v_cvt_pk_bf16_f32 v68, v168, v169
    v_cndmask_b32_e64 v15, v1, v2, vcc
    v_cvt_pk_bf16_f32 v69, v170, v171
    v_cvt_pk_bf16_f32 v70, v172, v173
    v_cvt_pk_bf16_f32 v71, v174, v175
    v_mfma_f32_32x32x16_bf16 v[144:159], a[104:107], v[80:83], v[144:159]
    v_exp_f32 v112, v112
    v_exp_f32 v113, v113
    v_exp_f32 v114, v114
    v_exp_f32 v115, v115
    v_mfma_f32_32x32x16_bf16 v[144:159], a[108:111], v[84:87], v[144:159]
    v_exp_f32 v116, v116
    v_exp_f32 v117, v117
    v_exp_f32 v118, v118
    v_mfma_f32_32x32x16_bf16 v[144:159], a[112:115], v[88:91], v[144:159]
    v_exp_f32 v119, v119
    v_exp_f32 v120, v120
    v_exp_f32 v121, v121
    v_exp_f32 v122, v122
    v_mfma_f32_32x32x16_bf16 v[144:159], a[116:119], v[92:95], v[144:159]
    v_exp_f32 v123, v123
    v_exp_f32 v124, v124
    v_exp_f32 v125, v125
    v_exp_f32 v126, v126
    v_exp_f32 v127, v127
    v_pk_add_f32 v[112:113], v[112:113], s[60:61]
    v_pk_add_f32 v[114:115], v[114:115], s[60:61]
    v_pk_add_f32 v[116:117], v[116:117], s[60:61]
    v_pk_add_f32 v[118:119], v[118:119], s[60:61]
    v_pk_add_f32 v[120:121], v[120:121], s[60:61]
    v_pk_add_f32 v[122:123], v[122:123], s[60:61]
    v_pk_add_f32 v[124:125], v[124:125], s[60:61]
    v_pk_add_f32 v[126:127], v[126:127], s[60:61]
    v_mfma_f32_32x32x16_bf16 v[176:191], a[184:187], v[64:67], v[176:191]
    buffer_store_dwordx4 v[48:51], v14, s[44:47], s71 offen offset:2048 sc0 sc1
    ds_read_b128 v[96:99], v4 offset:512
    ds_read_b128 v[100:103], v4 offset:544
    v_bfe_u32 v37, v1, 6, 1
    v_lshl_add_u32 v36, v37, 5, v36
    v_mfma_f32_32x32x16_bf16 v[176:191], a[188:191], v[68:71], v[176:191]
    ds_read_b128 v[104:107], v4 offset:576
    ds_read_b128 v[108:111], v4 offset:608
    v_bfe_u32 v37, v1, 7, 1
    v_mad_u32_u24 v36, v37, s100, v36
    v_add_u32 v13, s3, v36
    v_mov_b32 v36, 0
    v_mfma_f32_32x32x16_bf16 v[192:207], a[192:195], v[64:67], v[192:207]
    v_rcp_f32 v112, v112
    v_rcp_f32 v113, v113
    v_rcp_f32 v114, v114
    v_mfma_f32_32x32x16_bf16 v[192:207], a[196:199], v[68:71], v[192:207]
    buffer_store_dwordx4 v[52:55], v15, s[44:47], s71 offen offset:3072 sc0 sc1
    v_rcp_f32 v115, v115
    v_rcp_f32 v116, v116
    v_rcp_f32 v117, v117
    v_mfma_f32_32x32x16_bf16 v[208:223], a[200:203], v[64:67], v[208:223]
    v_rcp_f32 v118, v118
    v_rcp_f32 v119, v119
    v_rcp_f32 v120, v120
    v_mfma_f32_32x32x16_bf16 v[208:223], a[204:207], v[68:71], v[208:223]
    s_waitcnt lgkmcnt(0)
    v_rcp_f32 v121, v121
    v_rcp_f32 v122, v122
    v_rcp_f32 v123, v123
    v_rcp_f32 v124, v124
    v_rcp_f32 v125, v125
    v_rcp_f32 v126, v126
    v_rcp_f32_e64 v127, v127
    v_pk_mul_f32 v[128:129], v[128:129], v[112:113]
    v_pk_mul_f32 v[130:131], v[130:131], v[114:115]
    v_pk_mul_f32 v[132:133], v[132:133], v[116:117]
    v_pk_mul_f32 v[134:135], v[134:135], v[118:119]
    v_pk_mul_f32 v[136:137], v[136:137], v[120:121]
    v_pk_mul_f32 v[138:139], v[138:139], v[122:123]
    v_pk_mul_f32 v[140:141], v[140:141], v[124:125]
    v_pk_mul_f32 v[142:143], v[142:143], v[126:127]
    v_pk_fma_f32 v[112:113], v[144:145], v[144:145], s[58:59] neg_lo:[1,0,0] neg_hi:[1,0,0]
    v_pk_fma_f32 v[114:115], v[146:147], v[146:147], s[58:59] neg_lo:[1,0,0] neg_hi:[1,0,0]
    v_pk_fma_f32 v[116:117], v[148:149], v[148:149], s[58:59] neg_lo:[1,0,0] neg_hi:[1,0,0]
    v_pk_fma_f32 v[118:119], v[150:151], v[150:151], s[58:59] neg_lo:[1,0,0] neg_hi:[1,0,0]
    v_pk_fma_f32 v[120:121], v[152:153], v[152:153], s[58:59] neg_lo:[1,0,0] neg_hi:[1,0,0]
    v_pk_fma_f32 v[122:123], v[154:155], v[154:155], s[58:59] neg_lo:[1,0,0] neg_hi:[1,0,0]
    v_pk_fma_f32 v[124:125], v[156:157], v[156:157], s[58:59] neg_lo:[1,0,0] neg_hi:[1,0,0]
    v_pk_fma_f32 v[126:127], v[158:159], v[158:159], s[58:59] neg_lo:[1,0,0] neg_hi:[1,0,0]
    v_pk_mul_f32 v[112:113], v[112:113], v[144:145]
    v_pk_mul_f32 v[114:115], v[114:115], v[146:147]
    v_pk_mul_f32 v[116:117], v[116:117], v[148:149]
    v_pk_mul_f32 v[118:119], v[118:119], v[150:151]
    v_pk_mul_f32 v[120:121], v[120:121], v[152:153]
    v_pk_mul_f32 v[122:123], v[122:123], v[154:155]
    v_pk_mul_f32 v[124:125], v[124:125], v[156:157]
    v_pk_mul_f32 v[126:127], v[126:127], v[158:159]
    v_mfma_f32_32x32x16_bf16 v[160:175], a[120:123], v[72:75], v[96:111]
    v_add_u32 v8, s82, v8
    v_add_u32 v9, s82, v9
    v_add_u32 v10, s82, v10
    v_cmp_le_i32 vcc, s66, v1
    v_cvt_pk_bf16_f32 v64, v128, v129
    v_cvt_pk_bf16_f32 v65, v130, v131
    v_mfma_f32_32x32x16_bf16 v[160:175], a[124:127], v[76:79], v[160:175]
    ds_read_b128 v[72:75], v24 offset:0
    v_cndmask_b32_e64 v32, v1, v2, vcc
    v_cvt_pk_bf16_f32 v66, v132, v133
    v_cvt_pk_bf16_f32 v67, v134, v135
    v_cvt_pk_bf16_f32 v68, v136, v137
    v_cvt_pk_bf16_f32 v69, v138, v139
    v_mfma_f32_32x32x16_bf16 v[160:175], a[128:131], v[80:83], v[160:175]
    ds_read_b128 v[76:79], v24 offset:6304
    v_cvt_pk_bf16_f32 v70, v140, v141
    v_cvt_pk_bf16_f32 v71, v142, v143
    v_exp_f32 v112, v112
    v_exp_f32 v113, v113
    v_mfma_f32_32x32x16_bf16 v[160:175], a[132:135], v[84:87], v[160:175]
    ds_read_b128 v[80:83], v24 offset:12608
    v_exp_f32 v114, v114
    v_exp_f32 v115, v115
    v_exp_f32 v116, v116
    v_exp_f32 v117, v117
    v_exp_f32 v118, v118
    v_mfma_f32_32x32x16_bf16 v[160:175], v[248:251], v[88:91], v[160:175]
    ds_read_b128 v[84:87], v24 offset:18912
    v_exp_f32 v119, v119
    v_exp_f32 v120, v120
    v_exp_f32 v121, v121
    v_exp_f32 v122, v122
    v_exp_f32 v123, v123
    v_mfma_f32_32x32x16_bf16 v[160:175], v[252:255], v[92:95], v[160:175]
    ds_read_b128 v[88:91], v24 offset:25216
    v_exp_f32 v124, v124
    v_exp_f32 v125, v125
    v_exp_f32 v126, v126
    v_exp_f32 v127, v127
    v_pk_add_f32 v[112:113], v[112:113], s[60:61]
    v_pk_add_f32 v[114:115], v[114:115], s[60:61]
    v_pk_add_f32 v[116:117], v[116:117], s[60:61]
    v_pk_add_f32 v[118:119], v[118:119], s[60:61]
    v_pk_add_f32 v[120:121], v[120:121], s[60:61]
    v_pk_add_f32 v[122:123], v[122:123], s[60:61]
    v_pk_add_f32 v[124:125], v[124:125], s[60:61]
    v_pk_add_f32 v[126:127], v[126:127], s[60:61]
    v_mfma_f32_32x32x16_bf16 v[176:191], a[208:211], v[64:67], v[176:191]
    ds_read_b128 v[92:95], v24 offset:31520
    v_add_u32 v6, s81, v6
    v_add_u32 v11, s80, v1
    v_rcp_f32 v112, v112
    v_mfma_f32_32x32x16_bf16 v[176:191], a[212:215], v[68:71], v[176:191]
    buffer_load_dwordx4 v[40:43], v12, s[20:23], s97 offen offset:0
    v_rcp_f32 v113, v113
    v_rcp_f32 v114, v114
    v_mul_f32 v144, v144, v112
    v_mfma_f32_32x32x16_bf16 v[192:207], a[216:219], v[64:67], v[192:207]
L_pad5:
    s_cbranch_execz L_back
    buffer_store_dwordx4 v[56:59], v32, s[44:47], s72 offen offset:0 sc0 sc1
    ds_read_b128 v[128:131], v31 offset:0
    v_mul_f32 v145, v145, v113
    v_rcp_f32 v115, v115
    v_rcp_f32 v116, v116
    v_mfma_f32_32x32x16_bf16 v[192:207], a[220:223], v[68:71], v[192:207]
    buffer_load_dwordx4 v[44:47], v12, s[20:23], s97 offen offset:16
    ds_read_b128 v[132:135], v31 offset:512
    v_rcp_f32 v117, v117
    v_rcp_f32 v118, v118
    v_rcp_f32 v119, v119
    v_mfma_f32_32x32x16_bf16 v[208:223], a[224:227], v[64:67], v[208:223]
    v_rcp_f32 v120, v120
    v_rcp_f32 v121, v121
    v_rcp_f32 v122, v122
    v_mfma_f32_32x32x16_bf16 v[208:223], a[228:231], v[68:71], v[208:223]
    ds_write_b32 v39, v36
    buffer_load_dwordx4 v[48:51], v12, s[20:23], s97 offen offset:32
    v_rcp_f32 v123, v123
    v_rcp_f32 v124, v124
    v_rcp_f32 v125, v125
    v_rcp_f32 v126, v126
    v_rcp_f32_e64 v127, v127
    v_pk_mul_f32 v[146:147], v[146:147], v[114:115]
    v_pk_mul_f32 v[148:149], v[148:149], v[116:117]
    v_pk_mul_f32 v[150:151], v[150:151], v[118:119]
    v_pk_mul_f32 v[152:153], v[152:153], v[120:121]
    v_pk_mul_f32 v[154:155], v[154:155], v[122:123]
    v_pk_mul_f32 v[156:157], v[156:157], v[124:125]
    v_pk_mul_f32 v[158:159], v[158:159], v[126:127]
    v_pk_fma_f32 v[112:113], v[160:161], v[160:161], s[58:59] neg_lo:[1,0,0] neg_hi:[1,0,0]
    v_pk_fma_f32 v[114:115], v[162:163], v[162:163], s[58:59] neg_lo:[1,0,0] neg_hi:[1,0,0]
    v_pk_fma_f32 v[116:117], v[164:165], v[164:165], s[58:59] neg_lo:[1,0,0] neg_hi:[1,0,0]
    v_pk_fma_f32 v[118:119], v[166:167], v[166:167], s[58:59] neg_lo:[1,0,0] neg_hi:[1,0,0]
    v_pk_fma_f32 v[120:121], v[168:169], v[168:169], s[58:59] neg_lo:[1,0,0] neg_hi:[1,0,0]
    v_pk_fma_f32 v[122:123], v[170:171], v[170:171], s[58:59] neg_lo:[1,0,0] neg_hi:[1,0,0]
    v_pk_fma_f32 v[124:125], v[172:173], v[172:173], s[58:59] neg_lo:[1,0,0] neg_hi:[1,0,0]
    v_pk_fma_f32 v[126:127], v[174:175], v[174:175], s[58:59] neg_lo:[1,0,0] neg_hi:[1,0,0]
    v_pk_mul_f32 v[112:113], v[112:113], v[160:161]
    v_pk_mul_f32 v[114:115], v[114:115], v[162:163]
    v_pk_mul_f32 v[116:117], v[116:117], v[164:165]
    v_pk_mul_f32 v[118:119], v[118:119], v[166:167]
    v_pk_mul_f32 v[120:121], v[120:121], v[168:169]
    v_pk_mul_f32 v[122:123], v[122:123], v[170:171]
    v_pk_mul_f32 v[124:125], v[124:125], v[172:173]
    v_pk_mul_f32 v[126:127], v[126:127], v[174:175]
    s_waitcnt lgkmcnt(1)
    v_mfma_f32_16x16x32_bf16 v[128:131], a[0:3], v[72:75], v[128:131]
    buffer_load_ushort v52, v28, s[20:23], 0 offen offset:0
    v_cmp_le_i32 vcc, s67, v1
    v_cvt_pk_bf16_f32 v64, v144, v145
    v_cvt_pk_bf16_f32 v65, v146, v147
    v_mfma_f32_16x16x32_bf16 v[132:135], a[96:99], v[72:75], v[132:135]
    ds_read_b128 v[72:75], v25 offset:0
    v_cndmask_b32_e64 v32, v1, v2, vcc
    v_mfma_f32_16x16x32_bf16 v[128:131], a[4:7], v[76:79], v[128:131]
    buffer_load_ushort v53, v28, s[20:23], 0 offen offset:192
    v_cvt_pk_bf16_f32 v66, v148, v149
    v_mfma_f32_16x16x32_bf16 v[132:135], a[100:103], v[76:79], v[132:135]
    ds_read_b128 v[76:79], v25 offset:6304
    v_cvt_pk_bf16_f32 v67, v150, v151
    v_mfma_f32_16x16x32_bf16 v[128:131], a[8:11], v[80:83], v[128:131]
    buffer_load_ushort v54, v28, s[20:23], 0 offen offset:384
    v_cvt_pk_bf16_f32 v68, v152, v153
    v_mfma_f32_16x16x32_bf16 v[132:135], a[104:107], v[80:83], v[132:135]
    ds_read_b128 v[80:83], v25 offset:12608
    v_cvt_pk_bf16_f32 v69, v154, v155
    v_mfma_f32_16x16x32_bf16 v[128:131], a[12:15], v[84:87], v[128:131]
    buffer_load_ushort v55, v28, s[20:23], 0 offen offset:576
    v_cvt_pk_bf16_f32 v70, v156, v157
    v_mfma_f32_16x16x32_bf16 v[132:135], a[108:111], v[84:87], v[132:135]
    ds_read_b128 v[84:87], v25 offset:18912
    v_cvt_pk_bf16_f32 v71, v158, v159
    v_mfma_f32_16x16x32_bf16 v[128:131], a[16:19], v[88:91], v[128:131]
    v_exp_f32 v112, v112
    v_mfma_f32_16x16x32_bf16 v[132:135], a[112:115], v[88:91], v[132:135]
    ds_read_b128 v[88:91], v25 offset:25216
    v_exp_f32 v113, v113
    v_mfma_f32_16x16x32_bf16 v[128:131], a[20:23], v[92:95], v[128:131]
    v_exp_f32 v114, v114
    v_mfma_f32_16x16x32_bf16 v[132:135], a[116:119], v[92:95], v[132:135]
    s_waitcnt lgkmcnt(4)
    ds_read_b128 v[92:95], v25 offset:31520
    v_exp_f32 v115, v115
    v_mfma_f32_16x16x32_bf16 v[128:131], a[48:51], v[72:75], v[128:131]
    s_waitcnt lgkmcnt(4)
    v_exp_f32 v116, v116
    v_mfma_f32_16x16x32_bf16 v[128:131], a[52:55], v[76:79], v[128:131]
    s_waitcnt lgkmcnt(3)
    v_exp_f32 v117, v117
    v_mfma_f32_16x16x32_bf16 v[128:131], a[56:59], v[80:83], v[128:131]
    s_waitcnt lgkmcnt(2)
    v_exp_f32 v118, v118
    v_mfma_f32_16x16x32_bf16 v[128:131], a[60:63], v[84:87], v[128:131]
    s_waitcnt lgkmcnt(1)
    v_exp_f32 v119, v119
    v_mfma_f32_16x16x32_bf16 v[128:131], a[64:67], v[88:91], v[128:131]
    s_waitcnt lgkmcnt(0)
    v_exp_f32 v120, v120
    v_mfma_f32_16x16x32_bf16 v[128:131], a[68:71], v[92:95], v[128:131]
    v_exp_f32 v121, v121
    v_exp_f32 v122, v122
    v_exp_f32 v123, v123
    v_exp_f32 v124, v124
    v_exp_f32 v125, v125
    v_exp_f32 v126, v126
    v_exp_f32 v127, v127
    v_pk_add_f32 v[112:113], v[112:113], s[60:61]
    v_pk_add_f32 v[114:115], v[114:115], s[60:61]
    v_pk_add_f32 v[116:117], v[116:117], s[60:61]
    v_pk_add_f32 v[118:119], v[118:119], s[60:61]
    v_pk_add_f32 v[120:121], v[120:121], s[60:61]
    v_pk_add_f32 v[122:123], v[122:123], s[60:61]
    v_pk_add_f32 v[124:125], v[124:125], s[60:61]
    v_pk_add_f32 v[126:127], v[126:127], s[60:61]
    v_pk_fma_f32 v[136:137], v[128:129], v[128:129], s[58:59] neg_lo:[1,0,0] neg_hi:[1,0,0]
    v_pk_fma_f32 v[138:139], v[130:131], v[130:131], s[58:59] neg_lo:[1,0,0] neg_hi:[1,0,0]
    v_pk_fma_f32 v[140:141], v[132:133], v[132:133], s[58:59] neg_lo:[1,0,0] neg_hi:[1,0,0]
    v_pk_fma_f32 v[142:143], v[134:135], v[134:135], s[58:59] neg_lo:[1,0,0] neg_hi:[1,0,0]
    v_pk_mul_f32 v[136:137], v[136:137], v[128:129]
    v_pk_mul_f32 v[138:139], v[138:139], v[130:131]
    v_pk_mul_f32 v[140:141], v[140:141], v[132:133]
    v_pk_mul_f32 v[142:143], v[142:143], v[134:135]
    v_mfma_f32_32x32x16_bf16 v[176:191], a[232:235], v[64:67], v[176:191]
    v_add_u32 v12, s79, v1
    v_add_u32 v14, s83, v1
    v_rcp_f32 v112, v112
    v_rcp_f32 v113, v113
    v_mfma_f32_32x32x16_bf16 v[176:191], a[236:239], v[68:71], v[176:191]
    v_rcp_f32 v114, v114
    v_rcp_f32 v115, v115
    v_rcp_f32 v116, v116
    v_rcp_f32 v117, v117
    v_mfma_f32_32x32x16_bf16 v[192:207], a[240:243], v[64:67], v[192:207]
    buffer_store_dwordx4 v[60:63], v32, s[44:47], s72 offen offset:1024 sc0 sc1
    v_rcp_f32 v118, v118
    v_rcp_f32 v119, v119
    v_rcp_f32 v120, v120
    v_rcp_f32 v121, v121
    v_mfma_f32_32x32x16_bf16 v[192:207], a[244:247], v[68:71], v[192:207]
    v_rcp_f32 v122, v122
    v_rcp_f32 v123, v123
    v_rcp_f32 v124, v124
    v_rcp_f32 v125, v125
    v_mfma_f32_32x32x16_bf16 v[208:223], a[248:251], v[64:67], v[208:223]
    ds_read_b32 v96, v29
    ds_read_b32 v97, v29 offset:576
    v_rcp_f32 v126, v126
    v_rcp_f32 v127, v127
    v_exp_f32 v136, v136
    v_exp_f32 v137, v137
    v_mfma_f32_32x32x16_bf16 v[208:223], a[252:255], v[68:71], v[208:223]
    v_exp_f32 v138, v138
    v_exp_f32 v139, v139
    v_exp_f32 v140, v140
    v_exp_f32 v141, v141
    v_exp_f32 v142, v142
    v_exp_f32 v143, v143
    v_pk_mul_f32 v[160:161], v[160:161], v[112:113]
    v_pk_mul_f32 v[162:163], v[162:163], v[114:115]
    v_pk_mul_f32 v[164:165], v[164:165], v[116:117]
    v_pk_mul_f32 v[166:167], v[166:167], v[118:119]
    v_pk_mul_f32 v[168:169], v[168:169], v[120:121]
    v_pk_mul_f32 v[170:171], v[170:171], v[122:123]
    v_pk_mul_f32 v[172:173], v[172:173], v[124:125]
    v_pk_mul_f32 v[174:175], v[174:175], v[126:127]
    v_pk_add_f32 v[136:137], v[136:137], s[60:61]
    v_pk_add_f32 v[138:139], v[138:139], s[60:61]
    v_pk_add_f32 v[140:141], v[140:141], s[60:61]
    v_pk_add_f32 v[142:143], v[142:143], s[60:61]
    v_cvt_pk_bf16_f32 v64, v160, v161
    v_cvt_pk_bf16_f32 v65, v162, v163
    v_cvt_pk_bf16_f32 v66, v164, v165
    v_cvt_pk_bf16_f32 v67, v166, v167
    v_cvt_pk_bf16_f32 v68, v168, v169
    v_cvt_pk_bf16_f32 v69, v170, v171
    v_cvt_pk_bf16_f32 v70, v172, v173
    v_cvt_pk_bf16_f32 v71, v174, v175
    v_mfma_f32_32x32x16_bf16 v[208:223], v[240:243], v[64:67], v[208:223]
    ds_read_b128 v[160:163], v5 offset:576
    ds_read_b128 v[164:167], v5 offset:592
    v_rcp_f32 v136, v136
    v_rcp_f32 v137, v137
    v_mfma_f32_32x32x16_bf16 v[208:223], v[244:247], v[68:71], v[208:223]
    ds_read_b128 v[168:171], v5 offset:608
    ds_read_b128 v[172:175], v5 offset:624
    v_rcp_f32 v138, v138
    v_rcp_f32 v139, v139
    v_mfma_f32_32x32x16_bf16 v[192:207], v[232:235], v[64:67], v[192:207]
    ds_read_b128 v[100:103], v5 offset:640
    ds_read_b128 v[104:107], v5 offset:656
    v_rcp_f32 v140, v140
    v_rcp_f32 v141, v141
    v_mfma_f32_32x32x16_bf16 v[192:207], v[236:239], v[68:71], v[192:207]
    v_rcp_f32 v142, v142
    v_rcp_f32 v143, v143
    v_mul_f32 v128, v128, v136
    v_mul_f32 v129, v129, v137
    v_mul_f32 v130, v130, v138
    v_mul_f32 v131, v131, v139
    v_mul_f32 v132, v132, v140
    v_mul_f32 v133, v133, v141
    v_mul_f32 v134, v134, v142
    v_mul_f32 v135, v135, v143
    v_mfma_f32_32x32x16_bf16 v[176:191], v[224:227], v[64:67], v[176:191]
    ds_write_b128 v12, v[220:223] offset:5120
    v_cvt_pk_bf16_f32 v32, v128, v129
    v_cvt_pk_bf16_f32 v33, v130, v131
    v_cvt_pk_bf16_f32 v34, v132, v133
    v_cvt_pk_bf16_f32 v35, v134, v135
    v_mfma_f32_32x32x16_bf16 v[176:191], v[228:231], v[68:71], v[176:191]
    ds_write_b64 v13, v[32:33]
    ds_write_b64 v13, v[34:35] offset:640
    ds_read_b64 v[72:73], v38 offset:0
    ds_read_b64 v[74:75], v38 offset:16
    ds_read_b64 v[76:77], v38 offset:32
    ds_read_b64 v[78:79], v38 offset:48
    ds_read_b64 v[80:81], v38 offset:320
    ds_read_b64 v[82:83], v38 offset:336
    ds_read_b64 v[84:85], v38 offset:352
    ds_read_b64 v[86:87], v38 offset:368
    ds_read_b64 v[88:89], v38 offset:640
    ds_read_b64 v[90:91], v38 offset:656
    ds_read_b64 v[92:93], v38 offset:672
    ds_read_b64 v[94:95], v38 offset:688
    s_waitcnt vmcnt(1) lgkmcnt(15)
    v_lshlrev_b32 v220, 16, v50
    v_and_b32 v221, 0xffff0000, v50
    v_lshlrev_b32 v222, 16, v51
    v_and_b32 v223, 0xffff0000, v51
    v_fmac_f32 v220, v104, v196
    v_fmac_f32 v221, v105, v197
    v_fmac_f32 v222, v106, v198
    v_fmac_f32 v223, v107, v199
    ds_write_b128 v12, v[216:219] offset:4096
    v_lshlrev_b32 v216, 16, v48
    v_and_b32 v217, 0xffff0000, v48
    v_lshlrev_b32 v218, 16, v49
    v_and_b32 v219, 0xffff0000, v49
    v_fmac_f32 v216, v100, v192
    v_fmac_f32 v217, v101, v193
    v_fmac_f32 v218, v102, v194
    v_fmac_f32 v219, v103, v195
    ds_write_b128 v12, v[212:215] offset:3072
    v_lshlrev_b32 v212, 16, v46
    v_and_b32 v213, 0xffff0000, v46
    v_lshlrev_b32 v214, 16, v47
    v_and_b32 v215, 0xffff0000, v47
    v_fmac_f32 v212, v172, v188
    v_fmac_f32 v213, v173, v189
    v_fmac_f32 v214, v174, v190
    v_fmac_f32 v215, v175, v191
    s_waitcnt lgkmcnt(10)
    v_mfma_f32_16x16x32_bf16 v[144:147], v[72:75], a[136:139], 0
    v_mfma_f32_16x16x32_bf16 v[148:151], v[72:75], a[144:147], 0
    ds_write_b128 v12, v[208:211] offset:2048
    v_lshlrev_b32 v208, 16, v44
    v_and_b32 v209, 0xffff0000, v44
    v_lshlrev_b32 v210, 16, v45
    v_and_b32 v211, 0xffff0000, v45
    v_fmac_f32 v208, v168, v184
    v_fmac_f32 v209, v169, v185
    v_fmac_f32 v210, v170, v186
    v_fmac_f32 v211, v171, v187
    v_mfma_f32_16x16x32_bf16 v[152:155], v[72:75], a[152:155], 0
    v_mfma_f32_16x16x32_bf16 v[144:147], v[76:79], a[140:143], v[144:147]
    ds_write_b128 v12, v[204:207] offset:1024
    v_lshlrev_b32 v204, 16, v42
    v_and_b32 v205, 0xffff0000, v42
    v_lshlrev_b32 v206, 16, v43
    v_and_b32 v207, 0xffff0000, v43
    v_fmac_f32 v204, v164, v180
    v_fmac_f32 v205, v165, v181
    v_fmac_f32 v206, v166, v182
    v_fmac_f32 v207, v167, v183
    v_mfma_f32_16x16x32_bf16 v[148:151], v[76:79], a[148:151], v[148:151]
    v_mfma_f32_16x16x32_bf16 v[152:155], v[76:79], a[156:159], v[152:155]
    ds_write_b128 v12, v[200:203] offset:0
    s_waitcnt lgkmcnt(9)
    v_mfma_f32_16x16x32_bf16 v[144:147], v[80:83], a[184:187], v[144:147]
    v_cmp_le_i32 vcc, s68, v1
    v_lshlrev_b32 v200, 16, v40
    v_mfma_f32_16x16x32_bf16 v[148:151], v[80:83], a[192:195], v[148:151]
    v_and_b32 v201, 0xffff0000, v40
    v_cndmask_b32 v15, v1, v2, vcc
    v_mfma_f32_16x16x32_bf16 v[152:155], v[80:83], a[200:203], v[152:155]
    v_lshlrev_b32 v202, 16, v41
    v_cmp_le_i32 vcc, s69, v1
    v_mfma_f32_16x16x32_bf16 v[144:147], v[84:87], a[188:191], v[144:147]
    v_and_b32 v203, 0xffff0000, v41
    v_fmac_f32 v200, v160, v176
    v_mfma_f32_16x16x32_bf16 v[148:151], v[84:87], a[196:199], v[148:151]
    s_waitcnt lgkmcnt(0)
    s_barrier
    v_cndmask_b32 v32, v1, v2, vcc
    v_mfma_f32_16x16x32_bf16 v[152:155], v[84:87], a[204:207], v[152:155]
    ds_read_b128 v[224:227], v11 offset:0
    ds_read_b128 v[228:231], v11 offset:1024
    v_fmac_f32 v201, v161, v177
    v_mfma_f32_16x16x32_bf16 v[144:147], v[88:91], a[232:235], v[144:147]
    ds_read_b128 v[232:235], v11 offset:2048
    ds_read_b128 v[236:239], v11 offset:3072
    v_cmp_le_i32 vcc, s70, v1
    v_mfma_f32_16x16x32_bf16 v[148:151], v[88:91], a[240:243], v[148:151]
    ds_read_b128 v[240:243], v11 offset:4096
    ds_read_b128 v[244:247], v11 offset:5120
    v_fmac_f32 v202, v162, v178
    v_mfma_f32_16x16x32_bf16 v[152:155], v[88:91], a[248:251], v[152:155]
    v_fmac_f32 v203, v163, v179
    v_cndmask_b32 v33, v1, v2, vcc
    v_mfma_f32_16x16x32_bf16 v[144:147], v[92:95], a[236:239], v[144:147]
    v_lshlrev_b32 v52, 16, v52
    v_lshlrev_b32 v53, 16, v53
    v_mfma_f32_16x16x32_bf16 v[148:151], v[92:95], a[244:247], v[148:151]
    v_lshlrev_b32 v54, 16, v54
    v_lshlrev_b32 v55, 16, v55
    v_mfma_f32_16x16x32_bf16 v[152:155], v[92:95], a[252:255], v[152:155]
    v_fmac_f32 v52, v96, v97
    v_fmac_f32 v53, v96, v97
    v_fmac_f32 v54, v96, v97
    v_fmac_f32 v55, v96, v97
    s_waitcnt lgkmcnt(0)
    v_pk_fma_f32 v[200:201], v[160:161], v[224:225], v[200:201]
    v_pk_fma_f32 v[202:203], v[162:163], v[226:227], v[202:203]
    v_pk_fma_f32 v[204:205], v[164:165], v[228:229], v[204:205]
    v_pk_fma_f32 v[206:207], v[166:167], v[230:231], v[206:207]
    v_cvt_pk_bf16_f32 v176, v200, v201
    v_cvt_pk_bf16_f32 v177, v202, v203
    v_cvt_pk_bf16_f32 v178, v204, v205
    v_cvt_pk_bf16_f32 v179, v206, v207
    ds_write_b128 v6, v[176:179] offset:0
    v_pk_fma_f32 v[208:209], v[168:169], v[232:233], v[208:209]
    v_pk_fma_f32 v[210:211], v[170:171], v[234:235], v[210:211]
    v_pk_fma_f32 v[212:213], v[172:173], v[236:237], v[212:213]
    v_pk_fma_f32 v[214:215], v[174:175], v[238:239], v[214:215]
    v_cvt_pk_bf16_f32 v180, v208, v209
    v_cvt_pk_bf16_f32 v181, v210, v211
    v_cvt_pk_bf16_f32 v182, v212, v213
    v_cvt_pk_bf16_f32 v183, v214, v215
    ds_write_b128 v6, v[180:183] offset:16
    v_pk_fma_f32 v[216:217], v[100:101], v[240:241], v[216:217]
    v_pk_fma_f32 v[218:219], v[102:103], v[242:243], v[218:219]
    v_pk_fma_f32 v[220:221], v[104:105], v[244:245], v[220:221]
    v_pk_fma_f32 v[222:223], v[106:107], v[246:247], v[222:223]
    v_cvt_pk_bf16_f32 v184, v216, v217
    v_cvt_pk_bf16_f32 v185, v218, v219
    v_cvt_pk_bf16_f32 v186, v220, v221
    v_cvt_pk_bf16_f32 v187, v222, v223
    ds_write_b128 v6, v[184:187] offset:32
    s_waitcnt lgkmcnt(0)
    s_barrier
    ds_read_b128 v[40:43], v8
    ds_read_b128 v[44:47], v9
    ds_read_b128 v[48:51], v10
    ds_write_b128 v14, v[144:147] offset:0
    ds_write_b128 v14, v[148:151] offset:1024
    s_waitcnt lgkmcnt(4)
    buffer_store_dwordx4 v[40:43], v15, s[44:47], s73 offen offset:0 sc0 sc1
    s_waitcnt lgkmcnt(3)
    buffer_store_dwordx4 v[44:47], v32, s[44:47], s73 offen offset:1024 sc0 sc1
    s_waitcnt lgkmcnt(2)
    buffer_store_dwordx4 v[48:51], v33, s[44:47], s73 offen offset:2048 sc0 sc1
    ds_write_b128 v14, v[152:155] offset:2048
    s_waitcnt lgkmcnt(0)
    s_barrier
    s_cmp_lg_u32 s50, 0
    s_cbranch_scc1 L_fin
    ds_read_b128 v[160:163], v26 offset:0
    ds_read_b128 v[164:167], v27 offset:3072
    ds_read_b128 v[168:171], v26 offset:6144
    ds_read_b128 v[172:175], v27 offset:9216
    s_mov_b32 exec_hi, 0xffff
    s_waitcnt lgkmcnt(2)
    v_pk_add_f32 v[160:161], v[160:161], v[164:165]
    v_pk_add_f32 v[162:163], v[162:163], v[166:167]
    s_waitcnt lgkmcnt(0)
    v_pk_add_f32 v[168:169], v[168:169], v[172:173]
    v_pk_add_f32 v[170:171], v[170:171], v[174:175]
    v_pk_add_f32 v[160:161], v[160:161], v[168:169]
    v_pk_add_f32 v[162:163], v[162:163], v[170:171]
    v_fma_f32 v160, v160, v97, v52
    v_fma_f32 v161, v161, v97, v53
    v_fma_f32 v162, v162, v97, v54
    v_fma_f32 v163, v163, v97, v55
    v_cvt_pk_bf16_f32 v160, v160, v161
    v_cvt_pk_bf16_f32 v162, v162, v163
    buffer_store_short v160, v28, s[44:47], 0 offen offset:0
    buffer_store_short_d16_hi v160, v28, s[44:47], 0 offen offset:192
    buffer_store_short v162, v28, s[44:47], 0 offen offset:384
    buffer_store_short_d16_hi v162, v28, s[44:47], 0 offen offset:576
L_fin:
L_end:
    s_endpgm
.section .rodata,"a"
.p2align 6
.amdhsa_kernel standalone__modern_conv_block_convnext__vision_kernel
  .amdhsa_next_free_vgpr 512
  .amdhsa_next_free_sgpr 102
  .amdhsa_accum_offset 256
  .amdhsa_group_segment_fixed_size 0
  .amdhsa_kernarg_size 80
  .amdhsa_user_sgpr_count 2
  .amdhsa_user_sgpr_kernarg_segment_ptr 1
  .amdhsa_system_sgpr_workgroup_id_x 1
  .amdhsa_float_denorm_mode_32 3
.end_amdhsa_kernel
```
